```python
import torch

def _softmax(x, axis=-1):
    return torch.softmax(x, dim=axis)
def _gelu(x):
    return torch.nn.functional.gelu(x, approximate="tanh")
def _silu(x):
    return torch.nn.functional.silu(x)
def _sigmoid(x):
    return torch.sigmoid(x)
def _layernorm(x, axis=-1, eps=1e-5):
    m = x.mean(dim=axis, keepdim=True)
    v = x.var(dim=axis, keepdim=True, unbiased=False)
    return (x - m) / torch.sqrt(v + eps)
def _scatter_add(tgt, idx, src, axis=0):
    return tgt.clone().index_add_(axis, idx, src)
def _segment_sum(src, seg, n):
    out = torch.zeros((n,) + src.shape[1:], dtype=src.dtype)
    return out.index_add_(0, seg, src)
def _pad(x, pw):
    flat = tuple(v for pair in reversed(pw) for v in pair)
    return torch.nn.functional.pad(x, flat)

kernel_name = 'gather_scatter__edge_featured_mpnn_gatedgcn__graph'

def setup_inputs():

    _w = (lambda a: (lambda t: t.to(torch.bfloat16) if t.is_floating_point() else t)(torch.as_tensor(a)))
    N, deg, D, De = 10000, 32, 128, max(0, 1)
    E = N * deg
    return {
        "x": _w((lambda *s: torch.randn(*s, dtype=torch.bfloat16) * 0.4)(N, D)),
        "e_attr": _w((lambda *s: torch.randn(*s, dtype=torch.bfloat16) * 1.6)(E, De)),
        "src": _w((lambda lo, hi, *s: torch.randint(lo, hi, s))(0, N, E).to(torch.int64)),
        "dst": _w((lambda lo, hi, *s: torch.randint(lo, hi, s))(0, N, E).to(torch.int64)),
        "w_a": _w((lambda *s: torch.randn(*s, dtype=torch.bfloat16) * 0.4)(D, D)),
        "w_b": _w((lambda *s: torch.randn(*s, dtype=torch.bfloat16) * 0.4)(D, D)),
        "w_c": _w((lambda *s: torch.randn(*s, dtype=torch.bfloat16) * 1.6)(De, D)),
        "w_u": _w((lambda *s: torch.randn(*s, dtype=torch.bfloat16) * 0.05)(D, D)),
        "w_v": _w((lambda *s: torch.randn(*s, dtype=torch.bfloat16) * 0.05)(D, D)),
    }

def reference(x, e_attr, src, dst, w_a, w_b, w_c, w_u, w_v):
    N, D = x.shape
    hv = x @ w_v
    g = x[dst] @ w_a + x[src] @ w_b + e_attr @ w_c
    eta = _sigmoid(g)
    denom = _segment_sum(eta, dst, N) + 1e-6
    eta_n = eta / denom[dst]
    agg = _segment_sum(eta_n * hv[src], dst, N)
    z = x @ w_u + agg
    relu_z = torch.where(z > 0, z, 0 * z)
    return x + relu_z
```

```asm
; @launch kernel=prep_kernel grid=(222,1,1) block=(512,1,1) lds=81920
; @launch kernel=agg_kernel grid=(256,1,1) block=(1024,1,1) lds=129536
.amdgcn_target "amdgcn-amd-amdhsa--gfx950"
.text
.globl prep_kernel
.p2align 8
.type prep_kernel,@function
prep_kernel:
    s_load_dwordx2 s[8:9], s[0:1], 88
    s_cmp_ge_u32 s2, 222
    s_cbranch_scc1 K1_exit
    v_and_b32 v1, 63, v0
    v_lshrrev_b32 v2, 6, v0
    s_nop 0
    v_readfirstlane_b32 s3, v2
    s_cmp_ge_u32 s2, 64
    s_cbranch_scc1 K1_gemm
    s_load_dwordx2 s[4:5], s[0:1], 8
    s_load_dwordx2 s[6:7], s[0:1], 16
    s_load_dwordx2 s[10:11], s[0:1], 24
    v_mov_b32 v4, 0
    v_and_b32 v3, 255, v0
    v_lshlrev_b32 v3, 2, v3
    ds_write_b32 v3, v4
    s_mul_i32 s28, s2, 20000
    s_mul_i32 s29, s2, 10000
    v_lshlrev_b32 v3, 2, v0
    v_lshlrev_b32 v8, 1, v0
    s_waitcnt lgkmcnt(0)
    s_mov_b32 s12, s10
    s_and_b32 s13, s11, 0xffff
    s_mov_b32 s14, 1280000
    s_mov_b32 s15, 0x00020000
    s_mov_b32 s16, s6
    s_and_b32 s17, s7, 0xffff
    s_mov_b32 s18, 1280000
    s_mov_b32 s19, 0x00020000
    s_mov_b32 s20, s4
    s_and_b32 s21, s5, 0xffff
    s_mov_b32 s22, 640000
    s_mov_b32 s23, 0x00020000
    s_mov_b32 s24, s8
    s_and_b32 s25, s9, 0xffff
    s_mov_b32 s26, 14680064
    s_mov_b32 s27, 0x00020000
    v_cmp_gt_u32 vcc, 392, v0
    s_mov_b64 s[60:61], vcc
    s_add_u32 s32, s28, 0
    buffer_load_dword v10, v3, s[12:15], s32 offen
    s_add_u32 s32, s28, 2048
    buffer_load_dword v11, v3, s[12:15], s32 offen
    s_add_u32 s32, s28, 4096
    buffer_load_dword v12, v3, s[12:15], s32 offen
    s_add_u32 s32, s28, 6144
    buffer_load_dword v13, v3, s[12:15], s32 offen
    s_add_u32 s32, s28, 8192
    buffer_load_dword v14, v3, s[12:15], s32 offen
    s_add_u32 s32, s28, 10240
    buffer_load_dword v15, v3, s[12:15], s32 offen
    s_add_u32 s32, s28, 12288
    buffer_load_dword v16, v3, s[12:15], s32 offen
    s_add_u32 s32, s28, 14336
    buffer_load_dword v17, v3, s[12:15], s32 offen
    s_add_u32 s32, s28, 16384
    buffer_load_dword v18, v3, s[12:15], s32 offen
    s_mov_b64 exec, s[60:61]
    s_add_u32 s32, s28, 18432
    buffer_load_dword v19, v3, s[12:15], s32 offen
    s_mov_b64 exec, -1
    s_add_u32 s32, s28, 0
    buffer_load_dword v20, v3, s[16:19], s32 offen
    s_add_u32 s33, s29, 0
    buffer_load_ushort v30, v8, s[20:23], s33 offen
    s_add_u32 s32, s28, 2048
    buffer_load_dword v21, v3, s[16:19], s32 offen
    s_add_u32 s33, s29, 1024
    buffer_load_ushort v31, v8, s[20:23], s33 offen
    s_add_u32 s32, s28, 4096
    buffer_load_dword v22, v3, s[16:19], s32 offen
    s_add_u32 s33, s29, 2048
    buffer_load_ushort v32, v8, s[20:23], s33 offen
    s_add_u32 s32, s28, 6144
    buffer_load_dword v23, v3, s[16:19], s32 offen
    s_add_u32 s33, s29, 3072
    buffer_load_ushort v33, v8, s[20:23], s33 offen
    s_add_u32 s32, s28, 8192
    buffer_load_dword v24, v3, s[16:19], s32 offen
    s_add_u32 s33, s29, 4096
    buffer_load_ushort v34, v8, s[20:23], s33 offen
    s_add_u32 s32, s28, 10240
    buffer_load_dword v25, v3, s[16:19], s32 offen
    s_add_u32 s33, s29, 5120
    buffer_load_ushort v35, v8, s[20:23], s33 offen
    s_add_u32 s32, s28, 12288
    buffer_load_dword v26, v3, s[16:19], s32 offen
    s_add_u32 s33, s29, 6144
    buffer_load_ushort v36, v8, s[20:23], s33 offen
    s_add_u32 s32, s28, 14336
    buffer_load_dword v27, v3, s[16:19], s32 offen
    s_add_u32 s33, s29, 7168
    buffer_load_ushort v37, v8, s[20:23], s33 offen
    s_add_u32 s32, s28, 16384
    buffer_load_dword v28, v3, s[16:19], s32 offen
    s_add_u32 s33, s29, 8192
    buffer_load_ushort v38, v8, s[20:23], s33 offen
    s_mov_b64 exec, s[60:61]
    s_add_u32 s32, s28, 18432
    buffer_load_dword v29, v3, s[16:19], s32 offen
    s_add_u32 s33, s29, 9216
    buffer_load_ushort v39, v8, s[20:23], s33 offen
    s_mov_b64 exec, -1
    s_barrier
    v_mov_b32 v9, 1
    s_mov_b32 s34, 429497
    s_movk_i32 s35, 625
    s_waitcnt vmcnt(29)
    v_mul_u32_u24 v50, s34, v10
    v_lshrrev_b32 v50, 24, v50
    v_mul_u32_u24 v60, s35, v50
    v_lshlrev_b32 v50, 2, v50
    ds_add_rtn_u32 v40, v50, v9
    v_add_u32 v60, 15, v60
    v_lshrrev_b32 v60, 4, v60
    v_sub_u32 v10, v10, v60
    s_waitcnt vmcnt(28)
    v_mul_u32_u24 v51, s34, v11
    v_lshrrev_b32 v51, 24, v51
    v_mul_u32_u24 v60, s35, v51
    v_lshlrev_b32 v51, 2, v51
    ds_add_rtn_u32 v41, v51, v9
    v_add_u32 v60, 15, v60
    v_lshrrev_b32 v60, 4, v60
    v_sub_u32 v11, v11, v60
    s_waitcnt vmcnt(27)
    v_mul_u32_u24 v52, s34, v12
    v_lshrrev_b32 v52, 24, v52
    v_mul_u32_u24 v60, s35, v52
    v_lshlrev_b32 v52, 2, v52
    ds_add_rtn_u32 v42, v52, v9
    v_add_u32 v60, 15, v60
    v_lshrrev_b32 v60, 4, v60
    v_sub_u32 v12, v12, v60
    s_waitcnt vmcnt(26)
    v_mul_u32_u24 v53, s34, v13
    v_lshrrev_b32 v53, 24, v53
    v_mul_u32_u24 v60, s35, v53
    v_lshlrev_b32 v53, 2, v53
    ds_add_rtn_u32 v43, v53, v9
    v_add_u32 v60, 15, v60
    v_lshrrev_b32 v60, 4, v60
    v_sub_u32 v13, v13, v60
    s_waitcnt vmcnt(25)
    v_mul_u32_u24 v54, s34, v14
    v_lshrrev_b32 v54, 24, v54
    v_mul_u32_u24 v60, s35, v54
    v_lshlrev_b32 v54, 2, v54
    ds_add_rtn_u32 v44, v54, v9
    v_add_u32 v60, 15, v60
    v_lshrrev_b32 v60, 4, v60
    v_sub_u32 v14, v14, v60
    s_waitcnt vmcnt(24)
    v_mul_u32_u24 v55, s34, v15
    v_lshrrev_b32 v55, 24, v55
    v_mul_u32_u24 v60, s35, v55
    v_lshlrev_b32 v55, 2, v55
    ds_add_rtn_u32 v45, v55, v9
    v_add_u32 v60, 15, v60
    v_lshrrev_b32 v60, 4, v60
    v_sub_u32 v15, v15, v60
    s_waitcnt vmcnt(23)
    v_mul_u32_u24 v56, s34, v16
    v_lshrrev_b32 v56, 24, v56
    v_mul_u32_u24 v60, s35, v56
    v_lshlrev_b32 v56, 2, v56
    ds_add_rtn_u32 v46, v56, v9
    v_add_u32 v60, 15, v60
    v_lshrrev_b32 v60, 4, v60
    v_sub_u32 v16, v16, v60
    s_waitcnt vmcnt(22)
    v_mul_u32_u24 v57, s34, v17
    v_lshrrev_b32 v57, 24, v57
    v_mul_u32_u24 v60, s35, v57
    v_lshlrev_b32 v57, 2, v57
    ds_add_rtn_u32 v47, v57, v9
    v_add_u32 v60, 15, v60
    v_lshrrev_b32 v60, 4, v60
    v_sub_u32 v17, v17, v60
    s_waitcnt vmcnt(21)
    v_mul_u32_u24 v58, s34, v18
    v_lshrrev_b32 v58, 24, v58
    v_mul_u32_u24 v60, s35, v58
    v_lshlrev_b32 v58, 2, v58
    ds_add_rtn_u32 v48, v58, v9
    v_add_u32 v60, 15, v60
    v_lshrrev_b32 v60, 4, v60
    v_sub_u32 v18, v18, v60
    s_waitcnt vmcnt(20)
    s_mov_b64 exec, s[60:61]
    v_mul_u32_u24 v59, s34, v19
    v_lshrrev_b32 v59, 24, v59
    v_mul_u32_u24 v60, s35, v59
    v_lshlrev_b32 v59, 2, v59
    ds_add_rtn_u32 v49, v59, v9
    v_add_u32 v60, 15, v60
    v_lshrrev_b32 v60, 4, v60
    v_sub_u32 v19, v19, v60
    s_mov_b64 exec, -1
    s_waitcnt lgkmcnt(0)
    s_barrier
    v_lshlrev_b32 v61, 4, v1
    ds_read_b128 v[64:67], v61
    s_waitcnt lgkmcnt(0)
    v_add_u32 v68, v64, v65
    v_add_u32 v69, v68, v66
    v_add_u32 v70, v69, v67
    v_mov_b32 v71, v70
    s_nop 1
    v_add_u32_dpp v71, v71, v71 row_shr:1 row_mask:0xf bank_mask:0xf bound_ctrl:0
    s_nop 1
    v_add_u32_dpp v71, v71, v71 row_shr:2 row_mask:0xf bank_mask:0xf bound_ctrl:0
    s_nop 1
    v_add_u32_dpp v71, v71, v71 row_shr:4 row_mask:0xf bank_mask:0xf bound_ctrl:0
    s_nop 1
    v_add_u32_dpp v71, v71, v71 row_shr:8 row_mask:0xf bank_mask:0xf bound_ctrl:0
    s_nop 1
    v_add_u32_dpp v71, v71, v71 row_bcast:15 row_mask:0xa bank_mask:0xf
    s_nop 1
    v_add_u32_dpp v71, v71, v71 row_bcast:31 row_mask:0xc bank_mask:0xf
    s_nop 1
    v_sub_u32 v72, v71, v70
    v_add_u32 v73, v72, v64
    v_add_u32 v74, v72, v68
    v_add_u32 v75, v72, v69
    ds_write_b128 v61, v[72:75] offset:1024
    s_cmp_lg_u32 s3, 0
    s_cbranch_scc1 K1_sort_nooff
    v_lshl_or_b32 v76, v64, 16, v72
    v_lshl_or_b32 v77, v65, 16, v73
    v_lshl_or_b32 v78, v66, 16, v74
    v_lshl_or_b32 v79, v67, 16, v75
    v_lshlrev_b32 v80, 10, v1
    s_lshl_b32 s37, s2, 2
    s_add_u32 s37, s37, 5373952
    buffer_store_dword v76, v80, s[24:27], s37 offen sc0 sc1
    buffer_store_dword v77, v80, s[24:27], s37 offen offset:256 sc0 sc1
    buffer_store_dword v78, v80, s[24:27], s37 offen offset:512 sc0 sc1
    buffer_store_dword v79, v80, s[24:27], s37 offen offset:768 sc0 sc1
K1_sort_nooff:
    s_waitcnt lgkmcnt(0)
    ds_read_b32 v60, v50 offset:1024
    ds_read_b32 v61, v51 offset:1024
    ds_read_b32 v62, v52 offset:1024
    ds_read_b32 v63, v53 offset:1024
    ds_read_b32 v64, v54 offset:1024
    ds_read_b32 v65, v55 offset:1024
    ds_read_b32 v66, v56 offset:1024
    ds_read_b32 v67, v57 offset:1024
    ds_read_b32 v68, v58 offset:1024
    s_mov_b64 exec, s[60:61]
    ds_read_b32 v69, v59 offset:1024
    s_mov_b64 exec, -1
    s_waitcnt vmcnt(0) lgkmcnt(0)
    v_add_u32 v60, v60, v40
    v_lshlrev_b32 v60, 3, v60
    v_lshl_or_b32 v70, v10, 16, v20
    v_lshlrev_b32 v71, 16, v30
    ds_write_b64 v60, v[70:71] offset:2048
    v_add_u32 v61, v61, v41
    v_lshlrev_b32 v61, 3, v61
    v_lshl_or_b32 v72, v11, 16, v21
    v_lshlrev_b32 v73, 16, v31
    ds_write_b64 v61, v[72:73] offset:2048
    v_add_u32 v62, v62, v42
    v_lshlrev_b32 v62, 3, v62
    v_lshl_or_b32 v70, v12, 16, v22
    v_lshlrev_b32 v71, 16, v32
    ds_write_b64 v62, v[70:71] offset:2048
    v_add_u32 v63, v63, v43
    v_lshlrev_b32 v63, 3, v63
    v_lshl_or_b32 v72, v13, 16, v23
    v_lshlrev_b32 v73, 16, v33
    ds_write_b64 v63, v[72:73] offset:2048
    v_add_u32 v64, v64, v44
    v_lshlrev_b32 v64, 3, v64
    v_lshl_or_b32 v70, v14, 16, v24
    v_lshlrev_b32 v71, 16, v34
    ds_write_b64 v64, v[70:71] offset:2048
    v_add_u32 v65, v65, v45
    v_lshlrev_b32 v65, 3, v65
    v_lshl_or_b32 v72, v15, 16, v25
    v_lshlrev_b32 v73, 16, v35
    ds_write_b64 v65, v[72:73] offset:2048
    v_add_u32 v66, v66, v46
    v_lshlrev_b32 v66, 3, v66
    v_lshl_or_b32 v70, v16, 16, v26
    v_lshlrev_b32 v71, 16, v36
    ds_write_b64 v66, v[70:71] offset:2048
    v_add_u32 v67, v67, v47
    v_lshlrev_b32 v67, 3, v67
    v_lshl_or_b32 v72, v17, 16, v27
    v_lshlrev_b32 v73, 16, v37
    ds_write_b64 v67, v[72:73] offset:2048
    v_add_u32 v68, v68, v48
    v_lshlrev_b32 v68, 3, v68
    v_lshl_or_b32 v70, v18, 16, v28
    v_lshlrev_b32 v71, 16, v38
    ds_write_b64 v68, v[70:71] offset:2048
    s_mov_b64 exec, s[60:61]
    v_add_u32 v69, v69, v49
    v_lshlrev_b32 v69, 3, v69
    v_lshl_or_b32 v72, v19, 16, v29
    v_lshlrev_b32 v73, 16, v39
    ds_write_b64 v69, v[72:73] offset:2048
    s_mov_b64 exec, -1
    s_waitcnt lgkmcnt(0)
    s_barrier
    v_lshlrev_b32 v3, 4, v0
    ds_read_b128 v[52:55], v3 offset:2048
    ds_read_b128 v[56:59], v3 offset:10240
    ds_read_b128 v[60:63], v3 offset:18432
    ds_read_b128 v[64:67], v3 offset:26624
    v_cmp_gt_u32 vcc, 452, v0
    s_mov_b64 exec, vcc
    ds_read_b128 v[68:71], v3 offset:34816
    s_mov_b64 exec, -1
    s_mul_i32 s37, s2, 40000
    s_add_u32 s37, s37, 5505024
    s_add_u32 s38, s37, 8192
    s_add_u32 s39, s37, 16384
    s_add_u32 s40, s37, 24576
    s_add_u32 s41, s37, 32768
    s_waitcnt lgkmcnt(4)
    buffer_store_dwordx4 v[52:55], v3, s[24:27], s37 offen sc0 sc1
    s_waitcnt lgkmcnt(3)
    buffer_store_dwordx4 v[56:59], v3, s[24:27], s38 offen sc0 sc1
    s_waitcnt lgkmcnt(2)
    buffer_store_dwordx4 v[60:63], v3, s[24:27], s39 offen sc0 sc1
    s_waitcnt lgkmcnt(1)
    buffer_store_dwordx4 v[64:67], v3, s[24:27], s40 offen sc0 sc1
    s_waitcnt lgkmcnt(0)
    s_mov_b64 exec, vcc
    buffer_store_dwordx4 v[68:71], v3, s[24:27], s41 offen sc0 sc1
    s_mov_b64 exec, -1
    s_endpgm
K1_gemm:
    s_sub_u32 s2, s2, 64
    s_load_dwordx2 s[4:5], s[0:1], 0
    s_load_dwordx4 s[40:43], s[0:1], 32
    s_load_dwordx4 s[44:47], s[0:1], 48
    s_load_dwordx2 s[48:49], s[0:1], 64
    v_lshlrev_b32 v3, 4, v0
    v_lshrrev_b32 v4, 4, v0
    v_and_b32 v5, 3, v4
    v_bfe_u32 v6, v4, 3, 1
    v_lshl_or_b32 v5, v6, 2, v5
    v_lshlrev_b32 v5, 5, v5
    v_xor_b32 v8, v3, v5
    s_waitcnt lgkmcnt(0)
    s_cmp_eq_u32 s2, 157
    s_cselect_b32 s12, s40, s42
    s_cselect_b32 s13, s41, s43
    s_cselect_b32 s16, s46, s48
    s_cselect_b32 s17, s47, s49
    s_and_b32 s13, s13, 0xffff
    s_mov_b32 s14, 32768
    s_mov_b32 s15, 0x00020000
    s_and_b32 s17, s17, 0xffff
    s_mov_b32 s18, 32768
    s_mov_b32 s19, 0x00020000
    s_mov_b32 s20, s4
    s_and_b32 s21, s5, 0xffff
    s_mov_b32 s22, 2560000
    s_mov_b32 s23, 0x00020000
    s_mov_b32 s24, s8
    s_and_b32 s25, s9, 0xffff
    s_mov_b32 s26, 14680064
    s_mov_b32 s27, 0x00020000
    s_movk_i32 s31, 0
    buffer_load_dwordx4 v[64:67], v3, s[12:15], s31 offen
    buffer_load_dwordx4 v[80:83], v3, s[16:19], s31 offen
    s_movk_i32 s31, 8192
    buffer_load_dwordx4 v[68:71], v3, s[12:15], s31 offen
    buffer_load_dwordx4 v[84:87], v3, s[16:19], s31 offen
    s_movk_i32 s31, 16384
    buffer_load_dwordx4 v[72:75], v3, s[12:15], s31 offen
    buffer_load_dwordx4 v[88:91], v3, s[16:19], s31 offen
    s_movk_i32 s31, 24576
    buffer_load_dwordx4 v[76:79], v3, s[12:15], s31 offen
    buffer_load_dwordx4 v[92:95], v3, s[16:19], s31 offen
    s_lshl_b32 s32, s2, 14
    s_add_u32 s33, s32, 8192
    buffer_load_dwordx4 v[96:99], v3, s[20:23], s32 offen
    buffer_load_dwordx4 v[100:103], v3, s[20:23], s33 offen
    v_and_b32 v9, 15, v4
    v_lshlrev_b32 v9, 4, v9
    v_xor_b32 v9, v3, v9
    v_lshrrev_b32 v6, 4, v1
    v_bfe_u32 v10, v1, 2, 2
    v_and_b32 v11, 1, v6
    v_lshl_or_b32 v11, v11, 2, v10
    v_xor_b32 v11, s3, v11
    v_lshlrev_b32 v11, 5, v11
    v_lshl_add_u32 v10, v6, 3, v10
    v_lshl_add_u32 v11, v10, 8, v11
    v_and_b32 v12, 3, v1
    v_lshl_add_u32 v11, v12, 3, v11
    v_and_b32 v12, 15, v1
    v_xor_b32 v13, v6, v12
    v_lshlrev_b32 v13, 4, v13
    v_lshl_add_u32 v13, v12, 8, v13
    v_xor_b32 v14, 0, v13
    v_xor_b32 v15, 64, v13
    v_xor_b32 v16, 128, v13
    v_xor_b32 v17, 192, v13
    v_mov_b32 v128, 0
    v_mov_b32 v129, 0
    v_mov_b32 v130, 0
    v_mov_b32 v131, 0
    v_mov_b32 v132, 0
    v_mov_b32 v133, 0
    v_mov_b32 v134, 0
    v_mov_b32 v135, 0
    v_mov_b32 v136, 0
    v_mov_b32 v137, 0
    v_mov_b32 v138, 0
    v_mov_b32 v139, 0
    v_mov_b32 v140, 0
    v_mov_b32 v141, 0
    v_mov_b32 v142, 0
    v_mov_b32 v143, 0
    v_mov_b32 v144, 0
    v_mov_b32 v145, 0
    v_mov_b32 v146, 0
    v_mov_b32 v147, 0
    v_mov_b32 v148, 0
    v_mov_b32 v149, 0
    v_mov_b32 v150, 0
    v_mov_b32 v151, 0
    v_mov_b32 v152, 0
    v_mov_b32 v153, 0
    v_mov_b32 v154, 0
    v_mov_b32 v155, 0
    v_mov_b32 v156, 0
    v_mov_b32 v157, 0
    v_mov_b32 v158, 0
    v_mov_b32 v159, 0
    s_waitcnt vmcnt(8)
    ds_write_b128 v8, v[64:67] offset:0
    ds_write_b128 v8, v[80:83] offset:32768
    s_waitcnt vmcnt(6)
    ds_write_b128 v8, v[68:71] offset:8192
    ds_write_b128 v8, v[84:87] offset:40960
    s_waitcnt vmcnt(4)
    ds_write_b128 v8, v[72:75] offset:16384
    ds_write_b128 v8, v[88:91] offset:49152
    s_waitcnt vmcnt(2)
    ds_write_b128 v8, v[76:79] offset:24576
    ds_write_b128 v8, v[92:95] offset:57344
    v_add_u32 v9, 0x10000, v9
    s_waitcnt vmcnt(1)
    ds_write_b128 v9, v[96:99]
    s_waitcnt vmcnt(0)
    ds_write_b128 v9, v[100:103] offset:8192
    s_waitcnt lgkmcnt(0)
    s_barrier
    ds_read_b64_tr_b16 v[64:65], v11 offset:0
    ds_read_b64_tr_b16 v[66:67], v11 offset:1024
    ds_read_b64_tr_b16 v[68:69], v11 offset:8192
    ds_read_b64_tr_b16 v[70:71], v11 offset:9216
    ds_read_b64_tr_b16 v[72:73], v11 offset:16384
    ds_read_b64_tr_b16 v[74:75], v11 offset:17408
    ds_read_b64_tr_b16 v[76:77], v11 offset:24576
    ds_read_b64_tr_b16 v[78:79], v11 offset:25600
    ds_read_b64_tr_b16 v[80:81], v11 offset:32768
    ds_read_b64_tr_b16 v[82:83], v11 offset:33792
    ds_read_b64_tr_b16 v[84:85], v11 offset:40960
    ds_read_b64_tr_b16 v[86:87], v11 offset:41984
    ds_read_b64_tr_b16 v[88:89], v11 offset:49152
    ds_read_b64_tr_b16 v[90:91], v11 offset:50176
    ds_read_b64_tr_b16 v[92:93], v11 offset:57344
    ds_read_b64_tr_b16 v[94:95], v11 offset:58368
    s_cmp_eq_u32 s2, 157
    s_cbranch_scc1 K1_fragprep
    v_add_u32 v14, 0x10000, v14
    v_add_u32 v15, 0x10000, v15
    v_add_u32 v16, 0x10000, v16
    v_add_u32 v17, 0x10000, v17
    ds_read_b128 v[96:99], v14 offset:0
    ds_read_b128 v[100:103], v15 offset:0
    ds_read_b128 v[104:107], v16 offset:0
    ds_read_b128 v[108:111], v17 offset:0
    ds_read_b128 v[112:115], v14 offset:4096
    ds_read_b128 v[116:119], v15 offset:4096
    ds_read_b128 v[120:123], v16 offset:4096
    ds_read_b128 v[124:127], v17 offset:4096
    v_lshlrev_b32 v18, 9, v12
    v_lshl_add_u32 v18, v6, 4, v18
    s_lshl_b32 s30, s3, 6
    v_add_u32 v18, s30, v18
    s_lshl_b32 s35, s2, 15
    s_mov_b32 s36, 0xbfb8aa3b
    s_waitcnt lgkmcnt(4)
    v_mfma_f32_16x16x32_bf16 v[128:131], v[64:67], v[96:99], v[128:131]
    v_mfma_f32_16x16x32_bf16 v[132:135], v[80:83], v[96:99], v[132:135]
    v_mfma_f32_16x16x32_bf16 v[128:131], v[68:71], v[100:103], v[128:131]
    v_mfma_f32_16x16x32_bf16 v[132:135], v[84:87], v[100:103], v[132:135]
    v_mfma_f32_16x16x32_bf16 v[128:131], v[72:75], v[104:107], v[128:131]
    v_mfma_f32_16x16x32_bf16 v[132:135], v[88:91], v[104:107], v[132:135]
    v_mfma_f32_16x16x32_bf16 v[128:131], v[76:79], v[108:111], v[128:131]
    v_mfma_f32_16x16x32_bf16 v[132:135], v[92:95], v[108:111], v[132:135]
    ds_read_b128 v[96:99], v14 offset:8192
    ds_read_b128 v[100:103], v15 offset:8192
    ds_read_b128 v[104:107], v16 offset:8192
    ds_read_b128 v[108:111], v17 offset:8192
    s_waitcnt lgkmcnt(4)
    v_mfma_f32_16x16x32_bf16 v[136:139], v[64:67], v[112:115], v[136:139]
    v_mfma_f32_16x16x32_bf16 v[140:143], v[80:83], v[112:115], v[140:143]
    v_mfma_f32_16x16x32_bf16 v[136:139], v[68:71], v[116:119], v[136:139]
    v_mfma_f32_16x16x32_bf16 v[140:143], v[84:87], v[116:119], v[140:143]
    v_mfma_f32_16x16x32_bf16 v[136:139], v[72:75], v[120:123], v[136:139]
    v_mfma_f32_16x16x32_bf16 v[140:143], v[88:91], v[120:123], v[140:143]
    v_mfma_f32_16x16x32_bf16 v[136:139], v[76:79], v[124:127], v[136:139]
    v_mfma_f32_16x16x32_bf16 v[140:143], v[92:95], v[124:127], v[140:143]
    ds_read_b128 v[112:115], v14 offset:12288
    ds_read_b128 v[116:119], v15 offset:12288
    ds_read_b128 v[120:123], v16 offset:12288
    ds_read_b128 v[124:127], v17 offset:12288
    s_waitcnt lgkmcnt(4)
    v_mfma_f32_16x16x32_bf16 v[144:147], v[64:67], v[96:99], v[144:147]
    v_mfma_f32_16x16x32_bf16 v[148:151], v[80:83], v[96:99], v[148:151]
    v_mfma_f32_16x16x32_bf16 v[144:147], v[68:71], v[100:103], v[144:147]
    v_mfma_f32_16x16x32_bf16 v[148:151], v[84:87], v[100:103], v[148:151]
    v_mfma_f32_16x16x32_bf16 v[144:147], v[72:75], v[104:107], v[144:147]
    v_mfma_f32_16x16x32_bf16 v[148:151], v[88:91], v[104:107], v[148:151]
    v_mfma_f32_16x16x32_bf16 v[144:147], v[76:79], v[108:111], v[144:147]
    v_mfma_f32_16x16x32_bf16 v[148:151], v[92:95], v[108:111], v[148:151]
    s_waitcnt lgkmcnt(0)
    v_mfma_f32_16x16x32_bf16 v[152:155], v[64:67], v[112:115], v[152:155]
    v_mfma_f32_16x16x32_bf16 v[156:159], v[80:83], v[112:115], v[156:159]
    v_mfma_f32_16x16x32_bf16 v[152:155], v[68:71], v[116:119], v[152:155]
    v_mfma_f32_16x16x32_bf16 v[156:159], v[84:87], v[116:119], v[156:159]
    v_mfma_f32_16x16x32_bf16 v[152:155], v[72:75], v[120:123], v[152:155]
    v_mfma_f32_16x16x32_bf16 v[156:159], v[88:91], v[120:123], v[156:159]
    v_mfma_f32_16x16x32_bf16 v[152:155], v[76:79], v[124:127], v[152:155]
    v_mfma_f32_16x16x32_bf16 v[156:159], v[92:95], v[124:127], v[156:159]
    s_nop 7
    s_mov_b64 s[38:39], 0
    s_mov_b32 s37, 0x42700000
    s_mov_b32 s40, 0x476a6000
    s_add_u32 s33, s35, 0
    v_mul_f32 v128, s36, v128
    v_cvt_f16_f32 v42, v132
    v_exp_f32 v46, v128
    v_cmp_nge_f32 vcc, s37, |v128|
    v_cmp_nge_f32 s[42:43], s40, |v132|
    v_sub_u32 v46, v46, v42
    s_or_b64 s[38:39], s[38:39], vcc
    v_add_u32 v46, 0x8000, v46
    s_or_b64 s[38:39], s[38:39], s[42:43]
    v_and_b32 v46, 0xffff0000, v46
    v_or_b32 v20, v46, v42
    v_mul_f32 v129, s36, v129
    v_cvt_f16_f32 v42, v133
    v_exp_f32 v46, v129
    v_cmp_nge_f32 vcc, s37, |v129|
    v_cmp_nge_f32 s[42:43], s40, |v133|
    v_sub_u32 v46, v46, v42
    s_or_b64 s[38:39], s[38:39], vcc
    v_add_u32 v46, 0x8000, v46
    s_or_b64 s[38:39], s[38:39], s[42:43]
    v_and_b32 v46, 0xffff0000, v46
    v_or_b32 v21, v46, v42
    v_mul_f32 v130, s36, v130
    v_cvt_f16_f32 v42, v134
    v_exp_f32 v46, v130
    v_cmp_nge_f32 vcc, s37, |v130|
    v_cmp_nge_f32 s[42:43], s40, |v134|
    v_sub_u32 v46, v46, v42
    s_or_b64 s[38:39], s[38:39], vcc
    v_add_u32 v46, 0x8000, v46
    s_or_b64 s[38:39], s[38:39], s[42:43]
    v_and_b32 v46, 0xffff0000, v46
    v_or_b32 v22, v46, v42
    v_mul_f32 v131, s36, v131
    v_cvt_f16_f32 v42, v135
    v_exp_f32 v46, v131
    v_cmp_nge_f32 vcc, s37, |v131|
    v_cmp_nge_f32 s[42:43], s40, |v135|
    v_sub_u32 v46, v46, v42
    s_or_b64 s[38:39], s[38:39], vcc
    v_add_u32 v46, 0x8000, v46
    s_or_b64 s[38:39], s[38:39], s[42:43]
    v_and_b32 v46, 0xffff0000, v46
    v_or_b32 v23, v46, v42
    buffer_store_dwordx4 v[20:23], v18, s[24:27], s33 offen sc0 sc1
    s_add_u32 s33, s35, 8192
    v_mul_f32 v136, s36, v136
    v_cvt_f16_f32 v42, v140
    v_exp_f32 v46, v136
    v_cmp_nge_f32 vcc, s37, |v136|
    v_cmp_nge_f32 s[42:43], s40, |v140|
    v_sub_u32 v46, v46, v42
    s_or_b64 s[38:39], s[38:39], vcc
    v_add_u32 v46, 0x8000, v46
    s_or_b64 s[38:39], s[38:39], s[42:43]
    v_and_b32 v46, 0xffff0000, v46
    v_or_b32 v24, v46, v42
    v_mul_f32 v137, s36, v137
    v_cvt_f16_f32 v42, v141
    v_exp_f32 v46, v137
    v_cmp_nge_f32 vcc, s37, |v137|
    v_cmp_nge_f32 s[42:43], s40, |v141|
    v_sub_u32 v46, v46, v42
    s_or_b64 s[38:39], s[38:39], vcc
    v_add_u32 v46, 0x8000, v46
    s_or_b64 s[38:39], s[38:39], s[42:43]
    v_and_b32 v46, 0xffff0000, v46
    v_or_b32 v25, v46, v42
    v_mul_f32 v138, s36, v138
    v_cvt_f16_f32 v42, v142
    v_exp_f32 v46, v138
    v_cmp_nge_f32 vcc, s37, |v138|
    v_cmp_nge_f32 s[42:43], s40, |v142|
    v_sub_u32 v46, v46, v42
    s_or_b64 s[38:39], s[38:39], vcc
    v_add_u32 v46, 0x8000, v46
    s_or_b64 s[38:39], s[38:39], s[42:43]
    v_and_b32 v46, 0xffff0000, v46
    v_or_b32 v26, v46, v42
    v_mul_f32 v139, s36, v139
    v_cvt_f16_f32 v42, v143
    v_exp_f32 v46, v139
    v_cmp_nge_f32 vcc, s37, |v139|
    v_cmp_nge_f32 s[42:43], s40, |v143|
    v_sub_u32 v46, v46, v42
    s_or_b64 s[38:39], s[38:39], vcc
    v_add_u32 v46, 0x8000, v46
    s_or_b64 s[38:39], s[38:39], s[42:43]
    v_and_b32 v46, 0xffff0000, v46
    v_or_b32 v27, v46, v42
    buffer_store_dwordx4 v[24:27], v18, s[24:27], s33 offen sc0 sc1
    s_add_u32 s33, s35, 16384
    v_mul_f32 v144, s36, v144
    v_cvt_f16_f32 v42, v148
    v_exp_f32 v46, v144
    v_cmp_nge_f32 vcc, s37, |v144|
    v_cmp_nge_f32 s[42:43], s40, |v148|
    v_sub_u32 v46, v46, v42
    s_or_b64 s[38:39], s[38:39], vcc
    v_add_u32 v46, 0x8000, v46
    s_or_b64 s[38:39], s[38:39], s[42:43]
    v_and_b32 v46, 0xffff0000, v46
    v_or_b32 v28, v46, v42
    v_mul_f32 v145, s36, v145
    v_cvt_f16_f32 v42, v149
    v_exp_f32 v46, v145
    v_cmp_nge_f32 vcc, s37, |v145|
    v_cmp_nge_f32 s[42:43], s40, |v149|
    v_sub_u32 v46, v46, v42
    s_or_b64 s[38:39], s[38:39], vcc
    v_add_u32 v46, 0x8000, v46
    s_or_b64 s[38:39], s[38:39], s[42:43]
    v_and_b32 v46, 0xffff0000, v46
    v_or_b32 v29, v46, v42
    v_mul_f32 v146, s36, v146
    v_cvt_f16_f32 v42, v150
    v_exp_f32 v46, v146
    v_cmp_nge_f32 vcc, s37, |v146|
    v_cmp_nge_f32 s[42:43], s40, |v150|
    v_sub_u32 v46, v46, v42
    s_or_b64 s[38:39], s[38:39], vcc
    v_add_u32 v46, 0x8000, v46
    s_or_b64 s[38:39], s[38:39], s[42:43]
    v_and_b32 v46, 0xffff0000, v46
    v_or_b32 v30, v46, v42
    v_mul_f32 v147, s36, v147
    v_cvt_f16_f32 v42, v151
    v_exp_f32 v46, v147
    v_cmp_nge_f32 vcc, s37, |v147|
    v_cmp_nge_f32 s[42:43], s40, |v151|
    v_sub_u32 v46, v46, v42
    s_or_b64 s[38:39], s[38:39], vcc
    v_add_u32 v46, 0x8000, v46
    s_or_b64 s[38:39], s[38:39], s[42:43]
    v_and_b32 v46, 0xffff0000, v46
    v_or_b32 v31, v46, v42
    buffer_store_dwordx4 v[28:31], v18, s[24:27], s33 offen sc0 sc1
    s_add_u32 s33, s35, 24576
    v_mul_f32 v152, s36, v152
    v_cvt_f16_f32 v42, v156
    v_exp_f32 v46, v152
    v_cmp_nge_f32 vcc, s37, |v152|
    v_cmp_nge_f32 s[42:43], s40, |v156|
    v_sub_u32 v46, v46, v42
    s_or_b64 s[38:39], s[38:39], vcc
    v_add_u32 v46, 0x8000, v46
    s_or_b64 s[38:39], s[38:39], s[42:43]
    v_and_b32 v46, 0xffff0000, v46
    v_or_b32 v32, v46, v42
    v_mul_f32 v153, s36, v153
    v_cvt_f16_f32 v42, v157
    v_exp_f32 v46, v153
    v_cmp_nge_f32 vcc, s37, |v153|
    v_cmp_nge_f32 s[42:43], s40, |v157|
    v_sub_u32 v46, v46, v42
    s_or_b64 s[38:39], s[38:39], vcc
    v_add_u32 v46, 0x8000, v46
    s_or_b64 s[38:39], s[38:39], s[42:43]
    v_and_b32 v46, 0xffff0000, v46
    v_or_b32 v33, v46, v42
    v_mul_f32 v154, s36, v154
    v_cvt_f16_f32 v42, v158
    v_exp_f32 v46, v154
    v_cmp_nge_f32 vcc, s37, |v154|
    v_cmp_nge_f32 s[42:43], s40, |v158|
    v_sub_u32 v46, v46, v42
    s_or_b64 s[38:39], s[38:39], vcc
    v_add_u32 v46, 0x8000, v46
    s_or_b64 s[38:39], s[38:39], s[42:43]
    v_and_b32 v46, 0xffff0000, v46
    v_or_b32 v34, v46, v42
    v_mul_f32 v155, s36, v155
    v_cvt_f16_f32 v42, v159
    v_exp_f32 v46, v155
    v_cmp_nge_f32 vcc, s37, |v155|
    v_cmp_nge_f32 s[42:43], s40, |v159|
    v_sub_u32 v46, v46, v42
    s_or_b64 s[38:39], s[38:39], vcc
    v_add_u32 v46, 0x8000, v46
    s_or_b64 s[38:39], s[38:39], s[42:43]
    v_and_b32 v46, 0xffff0000, v46
    v_or_b32 v35, v46, v42
    buffer_store_dwordx4 v[32:35], v18, s[24:27], s33 offen sc0 sc1
    s_cmp_lg_u64 s[38:39], 0
    s_cselect_b32 s41, 1, 0
    s_lshl_b32 s44, s2, 5
    s_lshl_b32 s45, s3, 2
    s_add_u32 s44, s44, s45
    s_add_u32 s44, s44, 5324800
    v_mov_b32 v40, s41
    v_mov_b32 v41, 0
    s_mov_b64 exec, 1
    buffer_store_dword v40, v41, s[24:27], s44 offen sc0 sc1
    s_mov_b64 exec, -1
    s_cmp_eq_u32 s41, 0
    s_cbranch_scc1 K1_gemm_end
    s_add_u32 s33, s35, 8388608
    v_cvt_pk_bf16_f32 v40, v132, v133
    v_cvt_pk_bf16_f32 v41, v134, v135
    v_and_b32 v42, 0xffff, v40
    v_and_b32 v46, 0x7fffffff, v128
    v_add_u32 v46, 0x8000, v46
    v_max_u32 v46, v46, v42
    v_sub_u32 v46, v46, v42
    v_and_b32 v46, 0xffff0000, v46
    v_and_b32 v47, 0x80000000, v128
    v_or3_b32 v20, v46, v47, v42
    v_lshrrev_b32 v43, 16, v40
    v_and_b32 v46, 0x7fffffff, v129
    v_add_u32 v46, 0x8000, v46
    v_max_u32 v46, v46, v43
    v_sub_u32 v46, v46, v43
    v_and_b32 v46, 0xffff0000, v46
    v_and_b32 v47, 0x80000000, v129
    v_or3_b32 v21, v46, v47, v43
    v_and_b32 v44, 0xffff, v41
    v_and_b32 v46, 0x7fffffff, v130
    v_add_u32 v46, 0x8000, v46
    v_max_u32 v46, v46, v44
    v_sub_u32 v46, v46, v44
    v_and_b32 v46, 0xffff0000, v46
    v_and_b32 v47, 0x80000000, v130
    v_or3_b32 v22, v46, v47, v44
    v_lshrrev_b32 v45, 16, v41
    v_and_b32 v46, 0x7fffffff, v131
    v_add_u32 v46, 0x8000, v46
    v_max_u32 v46, v46, v45
    v_sub_u32 v46, v46, v45
    v_and_b32 v46, 0xffff0000, v46
    v_and_b32 v47, 0x80000000, v131
    v_or3_b32 v23, v46, v47, v45
    buffer_store_dwordx4 v[20:23], v18, s[24:27], s33 offen sc0 sc1
    s_nop 1
    s_add_u32 s33, s35, 8396800
    v_cvt_pk_bf16_f32 v40, v140, v141
    v_cvt_pk_bf16_f32 v41, v142, v143
    v_and_b32 v42, 0xffff, v40
    v_and_b32 v46, 0x7fffffff, v136
    v_add_u32 v46, 0x8000, v46
    v_max_u32 v46, v46, v42
    v_sub_u32 v46, v46, v42
    v_and_b32 v46, 0xffff0000, v46
    v_and_b32 v47, 0x80000000, v136
    v_or3_b32 v24, v46, v47, v42
    v_lshrrev_b32 v43, 16, v40
    v_and_b32 v46, 0x7fffffff, v137
    v_add_u32 v46, 0x8000, v46
    v_max_u32 v46, v46, v43
    v_sub_u32 v46, v46, v43
    v_and_b32 v46, 0xffff0000, v46
    v_and_b32 v47, 0x80000000, v137
    v_or3_b32 v25, v46, v47, v43
    v_and_b32 v44, 0xffff, v41
    v_and_b32 v46, 0x7fffffff, v138
    v_add_u32 v46, 0x8000, v46
    v_max_u32 v46, v46, v44
    v_sub_u32 v46, v46, v44
    v_and_b32 v46, 0xffff0000, v46
    v_and_b32 v47, 0x80000000, v138
    v_or3_b32 v26, v46, v47, v44
    v_lshrrev_b32 v45, 16, v41
    v_and_b32 v46, 0x7fffffff, v139
    v_add_u32 v46, 0x8000, v46
    v_max_u32 v46, v46, v45
    v_sub_u32 v46, v46, v45
    v_and_b32 v46, 0xffff0000, v46
    v_and_b32 v47, 0x80000000, v139
    v_or3_b32 v27, v46, v47, v45
    buffer_store_dwordx4 v[24:27], v18, s[24:27], s33 offen sc0 sc1
    s_nop 1
    s_add_u32 s33, s35, 8404992
    v_cvt_pk_bf16_f32 v40, v148, v149
    v_cvt_pk_bf16_f32 v41, v150, v151
    v_and_b32 v42, 0xffff, v40
    v_and_b32 v46, 0x7fffffff, v144
    v_add_u32 v46, 0x8000, v46
    v_max_u32 v46, v46, v42
    v_sub_u32 v46, v46, v42
    v_and_b32 v46, 0xffff0000, v46
    v_and_b32 v47, 0x80000000, v144
    v_or3_b32 v28, v46, v47, v42
    v_lshrrev_b32 v43, 16, v40
    v_and_b32 v46, 0x7fffffff, v145
    v_add_u32 v46, 0x8000, v46
    v_max_u32 v46, v46, v43
    v_sub_u32 v46, v46, v43
    v_and_b32 v46, 0xffff0000, v46
    v_and_b32 v47, 0x80000000, v145
    v_or3_b32 v29, v46, v47, v43
    v_and_b32 v44, 0xffff, v41
    v_and_b32 v46, 0x7fffffff, v146
    v_add_u32 v46, 0x8000, v46
    v_max_u32 v46, v46, v44
    v_sub_u32 v46, v46, v44
    v_and_b32 v46, 0xffff0000, v46
    v_and_b32 v47, 0x80000000, v146
    v_or3_b32 v30, v46, v47, v44
    v_lshrrev_b32 v45, 16, v41
    v_and_b32 v46, 0x7fffffff, v147
    v_add_u32 v46, 0x8000, v46
    v_max_u32 v46, v46, v45
    v_sub_u32 v46, v46, v45
    v_and_b32 v46, 0xffff0000, v46
    v_and_b32 v47, 0x80000000, v147
    v_or3_b32 v31, v46, v47, v45
    buffer_store_dwordx4 v[28:31], v18, s[24:27], s33 offen sc0 sc1
    s_nop 1
    s_add_u32 s33, s35, 8413184
    v_cvt_pk_bf16_f32 v40, v156, v157
    v_cvt_pk_bf16_f32 v41, v158, v159
    v_and_b32 v42, 0xffff, v40
    v_and_b32 v46, 0x7fffffff, v152
    v_add_u32 v46, 0x8000, v46
    v_max_u32 v46, v46, v42
    v_sub_u32 v46, v46, v42
    v_and_b32 v46, 0xffff0000, v46
    v_and_b32 v47, 0x80000000, v152
    v_or3_b32 v32, v46, v47, v42
    v_lshrrev_b32 v43, 16, v40
    v_and_b32 v46, 0x7fffffff, v153
    v_add_u32 v46, 0x8000, v46
    v_max_u32 v46, v46, v43
    v_sub_u32 v46, v46, v43
    v_and_b32 v46, 0xffff0000, v46
    v_and_b32 v47, 0x80000000, v153
    v_or3_b32 v33, v46, v47, v43
    v_and_b32 v44, 0xffff, v41
    v_and_b32 v46, 0x7fffffff, v154
    v_add_u32 v46, 0x8000, v46
    v_max_u32 v46, v46, v44
    v_sub_u32 v46, v46, v44
    v_and_b32 v46, 0xffff0000, v46
    v_and_b32 v47, 0x80000000, v154
    v_or3_b32 v34, v46, v47, v44
    v_lshrrev_b32 v45, 16, v41
    v_and_b32 v46, 0x7fffffff, v155
    v_add_u32 v46, 0x8000, v46
    v_max_u32 v46, v46, v45
    v_sub_u32 v46, v46, v45
    v_and_b32 v46, 0xffff0000, v46
    v_and_b32 v47, 0x80000000, v155
    v_or3_b32 v35, v46, v47, v45
    buffer_store_dwordx4 v[32:35], v18, s[24:27], s33 offen sc0 sc1
    s_nop 1
K1_gemm_end:
    s_endpgm
K1_fragprep:
    v_lshlrev_b32 v3, 4, v1
    s_lshl_b32 s33, s3, 12
    s_add_u32 s33, s33, 5242880
    s_add_u32 s34, s33, 32768
    s_waitcnt lgkmcnt(0)
    buffer_store_dwordx4 v[64:67], v3, s[24:27], s33 offen offset:0 sc0 sc1
    buffer_store_dwordx4 v[68:71], v3, s[24:27], s33 offen offset:1024 sc0 sc1
    buffer_store_dwordx4 v[72:75], v3, s[24:27], s33 offen offset:2048 sc0 sc1
    buffer_store_dwordx4 v[76:79], v3, s[24:27], s33 offen offset:3072 sc0 sc1
    buffer_store_dwordx4 v[80:83], v3, s[24:27], s34 offen offset:0 sc0 sc1
    buffer_store_dwordx4 v[84:87], v3, s[24:27], s34 offen offset:1024 sc0 sc1
    buffer_store_dwordx4 v[88:91], v3, s[24:27], s34 offen offset:2048 sc0 sc1
    buffer_store_dwordx4 v[92:95], v3, s[24:27], s34 offen offset:3072 sc0 sc1
    s_cmp_lg_u32 s3, 0
    s_cbranch_scc1 K1_exit
    s_mov_b32 s12, s44
    s_and_b32 s13, s45, 0xffff
    s_mov_b32 s14, 256
    s_mov_b32 s15, 0x00020000
    s_mov_b32 s36, 0xbfb8aa3b
    v_lshlrev_b32 v3, 2, v1
    buffer_load_dword v4, v3, s[12:15], 0 offen
    v_mov_b32 v6, 0x7f000000
    v_mov_b32 v7, 0x7f000000
    v_lshlrev_b32 v8, 3, v1
    s_mov_b32 s33, 5144576
    buffer_store_dwordx2 v[6:7], v8, s[24:27], s33 offen sc0 sc1
    s_waitcnt vmcnt(1)
    v_lshlrev_b32 v12, 16, v4
    v_and_b32 v13, 0xffff0000, v4
    v_mul_f32 v12, s36, v12
    v_mul_f32 v13, s36, v13
    s_mov_b32 s33, 5308416
    buffer_store_dwordx2 v[12:13], v8, s[24:27], s33 offen sc0 sc1
K1_exit:
    s_endpgm
.globl agg_kernel
.p2align 8
.type agg_kernel,@function
agg_kernel:
    s_cmp_ge_u32 s2, 256
    s_cbranch_scc1 K2_exit
    s_load_dwordx2 s[4:5], s[0:1], 0
    s_load_dwordx2 s[6:7], s[0:1], 72
    s_load_dwordx2 s[8:9], s[0:1], 88
    v_lshrrev_b32 v2, 6, v0
    v_and_b32 v1, 63, v0
    v_readfirstlane_b32 s3, v2
    v_mov_b32 v4, 0
    v_lshlrev_b32 v3, 2, v0
    v_cmp_gt_u32 vcc, 64, v0
    s_mov_b64 exec, vcc
    ds_write_b32 v3, v4 offset:62208
    ds_write_b32 v3, v4 offset:62720
    s_mov_b64 exec, -1
    s_mul_i32 s100, s2, 625
    s_add_u32 s101, s100, 640
    s_add_u32 s100, s100, 15
    s_lshr_b32 s100, s100, 4
    s_lshr_b32 s101, s101, 4
    s_sub_u32 s101, s101, s100
    v_lshrrev_b32 v5, 3, v1
    s_lshl_b32 s24, s3, 3
    v_add_u32 v5, s24, v5
    v_lshlrev_b32 v6, 2, v5
    s_lshl_b32 s25, s2, 8
    s_add_u32 s25, s25, 5373952
    v_lshlrev_b32 v7, 4, v0
    v_bfe_u32 v8, v0, 4, 4
    v_lshlrev_b32 v8, 4, v8
    v_xor_b32 v8, v7, v8
    s_lshl_b32 s26, s100, 8
    v_lshlrev_b32 v9, 4, v1
    s_lshl_b32 s27, s3, 12
    s_add_u32 s27, s27, 5242880
    v_and_b32 v2, 31, v1
    v_lshlrev_b32 v2, 4, v2
    s_mov_b32 s35, 5308416
    s_waitcnt lgkmcnt(0)
    s_mov_b32 s12, s8
    s_and_b32 s13, s9, 0xffff
    s_mov_b32 s14, 14680064
    s_mov_b32 s15, 0x00020000
    s_mov_b32 s16, s4
    s_and_b32 s17, s5, 0xffff
    s_mov_b32 s18, 2560000
    s_mov_b32 s19, 0x00020000
    s_mov_b32 s20, s6
    s_and_b32 s21, s7, 0xffff
    s_mov_b32 s22, 2560000
    s_mov_b32 s23, 0x00020000
    v_lshlrev_b32 v10, 2, v0
    s_mov_b32 s36, 5324800
    s_cmp_ge_u32 s3, 8
    s_cbranch_scc1 K2_pref
    buffer_load_dword v56, v6, s[12:15], s25 offen
    buffer_load_dword v61, v10, s[12:15], s36 offen
    buffer_load_dword v62, v10, s[12:15], s36 offen offset:4096
    buffer_load_dwordx4 v[92:95], v7, s[16:19], s26 offen
    buffer_load_dwordx4 v[76:79], v9, s[12:15], s27 offen
    buffer_load_dwordx4 v[80:83], v9, s[12:15], s27 offen offset:1024
    buffer_load_dwordx4 v[84:87], v9, s[12:15], s27 offen offset:2048
    buffer_load_dwordx4 v[88:91], v9, s[12:15], s27 offen offset:3072
    buffer_load_dwordx4 v[12:15], v2, s[12:15], s35 offen
    s_barrier
    s_mov_b32 s28, 40000
    v_mul_lo_u32 v57, v5, s28
    v_and_b32 v58, 7, v1
    v_lshl_add_u32 v57, v58, 3, v57
    v_add_u32 v57, 5505024, v57
    s_waitcnt vmcnt(8)
    v_and_b32 v59, 0xffff, v56
    v_lshrrev_b32 v56, 16, v56
    v_lshl_add_u32 v57, v59, 3, v57
    v_cmp_lt_u32 vcc, 64, v56
    v_sub_u32 v56, v56, v58
    v_cmp_lt_i32 s[40:41], 0, v56
    v_cmp_lt_i32 s[42:43], 8, v56
    v_cmp_lt_i32 s[44:45], 16, v56
    v_cmp_lt_i32 s[46:47], 24, v56
    v_cmp_lt_i32 s[48:49], 32, v56
    v_cmp_lt_i32 s[50:51], 40, v56
    v_cmp_lt_i32 s[52:53], 48, v56
    v_cmp_lt_i32 s[54:55], 56, v56
    s_cmp_eq_u64 vcc, 0
    s_cbranch_scc1 K2_noslow
    v_mov_b32 v59, 62724
    v_mov_b32 v60, 1
    ds_write_b32 v59, v60
K2_noslow:
    s_mov_b32 s29, 0
    s_mov_b64 exec, s[40:41]
    s_cbranch_execz K2_ent_done
    buffer_load_dwordx2 v[24:25], v57, s[12:15], 0 offen offset:0
    s_add_u32 s29, s29, 1
    s_mov_b64 exec, s[42:43]
    s_cbranch_execz K2_ent_done
    buffer_load_dwordx2 v[26:27], v57, s[12:15], 0 offen offset:64
    s_add_u32 s29, s29, 1
    s_mov_b64 exec, s[44:45]
    s_cbranch_execz K2_ent_done
    buffer_load_dwordx2 v[28:29], v57, s[12:15], 0 offen offset:128
    s_add_u32 s29, s29, 1
    s_mov_b64 exec, s[46:47]
    s_cbranch_execz K2_ent_done
    buffer_load_dwordx2 v[30:31], v57, s[12:15], 0 offen offset:192
    s_add_u32 s29, s29, 1
    s_mov_b64 exec, s[48:49]
    s_cbranch_execz K2_ent_done
    buffer_load_dwordx2 v[32:33], v57, s[12:15], 0 offen offset:256
    s_add_u32 s29, s29, 1
    s_mov_b64 exec, s[50:51]
    s_cbranch_execz K2_ent_done
    buffer_load_dwordx2 v[34:35], v57, s[12:15], 0 offen offset:320
    s_add_u32 s29, s29, 1
    s_mov_b64 exec, s[52:53]
    s_cbranch_execz K2_ent_done
    buffer_load_dwordx2 v[36:37], v57, s[12:15], 0 offen offset:384
    s_add_u32 s29, s29, 1
    s_mov_b64 exec, s[54:55]
    s_cbranch_execz K2_ent_done
    buffer_load_dwordx2 v[38:39], v57, s[12:15], 0 offen offset:448
    s_add_u32 s29, s29, 1
K2_ent_done:
    s_mov_b64 exec, -1
    s_cmp_eq_u32 s29, 3
    s_cbranch_scc1 K2_w3
    s_cmp_eq_u32 s29, 2
    s_cbranch_scc1 K2_w2
    s_cmp_eq_u32 s29, 4
    s_cbranch_scc1 K2_w4
    s_cmp_eq_u32 s29, 1
    s_cbranch_scc1 K2_w1
    s_cmp_eq_u32 s29, 5
    s_cbranch_scc1 K2_w5
    s_cmp_eq_u32 s29, 6
    s_cbranch_scc1 K2_w6
    s_cmp_eq_u32 s29, 7
    s_cbranch_scc1 K2_w7
    s_cmp_eq_u32 s29, 8
    s_cbranch_scc1 K2_w8
    s_waitcnt vmcnt(0)
    s_branch K2_wdone
K2_w1:
    s_waitcnt vmcnt(1)
    s_branch K2_wdone
K2_w2:
    s_waitcnt vmcnt(2)
    s_branch K2_wdone
K2_w3:
    s_waitcnt vmcnt(3)
    s_branch K2_wdone
K2_w4:
    s_waitcnt vmcnt(4)
    s_branch K2_wdone
K2_w5:
    s_waitcnt vmcnt(5)
    s_branch K2_wdone
K2_w6:
    s_waitcnt vmcnt(6)
    s_branch K2_wdone
K2_w7:
    s_waitcnt vmcnt(7)
    s_branch K2_wdone
K2_w8:
    s_waitcnt vmcnt(8)
    s_branch K2_wdone
K2_pref:
    buffer_load_dword v61, v10, s[12:15], s36 offen
    v_mov_b32 v62, 0
    v_cmp_gt_u32 vcc, 768, v0
    s_mov_b64 exec, vcc
    s_cbranch_execz K2_nox
    buffer_load_dwordx4 v[92:95], v7, s[16:19], s26 offen
K2_nox:
    s_mov_b64 exec, -1
    buffer_load_dwordx4 v[76:79], v9, s[12:15], s27 offen
    buffer_load_dwordx4 v[80:83], v9, s[12:15], s27 offen offset:1024
    buffer_load_dwordx4 v[84:87], v9, s[12:15], s27 offen offset:2048
    buffer_load_dwordx4 v[88:91], v9, s[12:15], s27 offen offset:3072
    buffer_load_dwordx4 v[12:15], v2, s[12:15], s35 offen
    s_lshr_b32 s28, s2, 3
    s_mul_i32 s28, s28, 0
    s_sub_u32 s29, s3, 8
    s_mul_i32 s29, s29, 0
    s_add_u32 s28, s28, s29
    s_mov_b64 s[40:41], 0
    s_mov_b64 s[42:43], 0
    s_mov_b64 s[44:45], 0
    s_mov_b64 s[46:47], 0
    s_mov_b64 s[48:49], 0
    s_mov_b64 s[50:51], 0
    s_mov_b64 s[52:53], 0
    s_mov_b64 s[54:55], 0
    s_barrier
    s_waitcnt vmcnt(0)
K2_wdone:
    v_cmp_gt_u32 vcc, 232, v0
    s_nop 1
    v_cndmask_b32 v62, 0, v62, vcc
    v_or_b32 v61, v61, v62
    v_cmp_ne_u32 vcc, 0, v61
    s_cmp_eq_u64 vcc, 0
    s_cbranch_scc1 K2_noflag
    v_mov_b32 v59, 62724
    v_mov_b32 v60, 1
    ds_write_b32 v59, v60
K2_noflag:
    v_cmp_gt_u32 vcc, 768, v0
    s_mov_b64 exec, vcc
    ds_write_b128 v8, v[92:95] offset:0
    s_mov_b64 exec, -1
    s_waitcnt lgkmcnt(0)
    s_barrier
    v_lshrrev_b32 v6, 4, v1
    v_and_b32 v10, 15, v1
    v_xor_b32 v11, v6, v10
    v_lshlrev_b32 v11, 4, v11
    v_lshl_add_u32 v11, v10, 8, v11
    v_xor_b32 v16, 0, v11
    v_xor_b32 v17, 64, v11
    v_xor_b32 v18, 128, v11
    v_xor_b32 v19, 192, v11
    v_mov_b32 v96, 0
    v_mov_b32 v97, 0
    v_mov_b32 v98, 0
    v_mov_b32 v99, 0
    v_mov_b32 v100, 0
    v_mov_b32 v101, 0
    v_mov_b32 v102, 0
    v_mov_b32 v103, 0
    v_mov_b32 v104, 0
    v_mov_b32 v105, 0
    v_mov_b32 v106, 0
    v_mov_b32 v107, 0
    ds_read_b128 v[108:111], v16 offset:0
    ds_read_b128 v[112:115], v17 offset:0
    ds_read_b128 v[116:119], v18 offset:0
    ds_read_b128 v[120:123], v19 offset:0
    s_waitcnt lgkmcnt(0)
    v_mfma_f32_16x16x32_bf16 v[96:99], v[76:79], v[108:111], v[96:99]
    v_mfma_f32_16x16x32_bf16 v[96:99], v[80:83], v[112:115], v[96:99]
    v_mfma_f32_16x16x32_bf16 v[96:99], v[84:87], v[116:119], v[96:99]
    v_mfma_f32_16x16x32_bf16 v[96:99], v[88:91], v[120:123], v[96:99]
    s_nop 1
    ds_read_b128 v[108:111], v16 offset:4096
    ds_read_b128 v[112:115], v17 offset:4096
    ds_read_b128 v[116:119], v18 offset:4096
    ds_read_b128 v[120:123], v19 offset:4096
    s_waitcnt lgkmcnt(0)
    v_mfma_f32_16x16x32_bf16 v[100:103], v[76:79], v[108:111], v[100:103]
    v_mfma_f32_16x16x32_bf16 v[100:103], v[80:83], v[112:115], v[100:103]
    v_mfma_f32_16x16x32_bf16 v[100:103], v[84:87], v[116:119], v[100:103]
    v_mfma_f32_16x16x32_bf16 v[100:103], v[88:91], v[120:123], v[100:103]
    s_nop 1
    ds_read_b128 v[108:111], v16 offset:8192
    ds_read_b128 v[112:115], v17 offset:8192
    ds_read_b128 v[116:119], v18 offset:8192
    ds_read_b128 v[120:123], v19 offset:8192
    s_waitcnt lgkmcnt(0)
    v_mfma_f32_16x16x32_bf16 v[104:107], v[76:79], v[108:111], v[104:107]
    v_mfma_f32_16x16x32_bf16 v[104:107], v[80:83], v[112:115], v[104:107]
    v_mfma_f32_16x16x32_bf16 v[104:107], v[84:87], v[116:119], v[104:107]
    v_mfma_f32_16x16x32_bf16 v[104:107], v[88:91], v[120:123], v[104:107]
    s_nop 1
    s_mov_b32 s30, 0xbfb8aa3b
    s_cmp_lt_u32 s3, 8
    s_cselect_b32 s30, s30, 1.0
    s_movk_i32 s31, 1040
    v_mul_u32_u24 v11, s31, v10
    v_lshl_add_u32 v11, v6, 4, v11
    s_lshl_b32 s31, s3, 6
    v_add_u32 v11, s31, v11
    s_nop 4
    v_mul_f32 v96, s30, v96
    v_mul_f32 v97, s30, v97
    v_mul_f32 v98, s30, v98
    v_mul_f32 v99, s30, v99
    v_mul_f32 v100, s30, v100
    v_mul_f32 v101, s30, v101
    v_mul_f32 v102, s30, v102
    v_mul_f32 v103, s30, v103
    v_mul_f32 v104, s30, v104
    v_mul_f32 v105, s30, v105
    v_mul_f32 v106, s30, v106
    v_mul_f32 v107, s30, v107
    ds_write_b128 v11, v[96:99] offset:12288
    ds_write_b128 v11, v[100:103] offset:28928
    ds_write_b128 v11, v[104:107] offset:45568
    s_cmp_ge_u32 s3, 8
    s_cbranch_scc1 K2_at_done
    s_waitcnt vmcnt(0)
    v_mov_b32 v9, 1
    s_mov_b64 exec, s[40:41]
    s_cbranch_execz K2_at_done
    v_lshrrev_b32 v64, 16, v24
    v_lshlrev_b32 v64, 2, v64
    ds_add_rtn_u32 v72, v64, v9 offset:62208
    s_mov_b64 exec, s[42:43]
    s_cbranch_execz K2_at_done
    v_lshrrev_b32 v65, 16, v26
    v_lshlrev_b32 v65, 2, v65
    ds_add_rtn_u32 v73, v65, v9 offset:62208
    s_mov_b64 exec, s[44:45]
    s_cbranch_execz K2_at_done
    v_lshrrev_b32 v66, 16, v28
    v_lshlrev_b32 v66, 2, v66
    ds_add_rtn_u32 v74, v66, v9 offset:62208
    s_mov_b64 exec, s[46:47]
    s_cbranch_execz K2_at_done
    v_lshrrev_b32 v67, 16, v30
    v_lshlrev_b32 v67, 2, v67
    ds_add_rtn_u32 v75, v67, v9 offset:62208
    s_mov_b64 exec, s[48:49]
    s_cbranch_execz K2_at_done
    v_lshrrev_b32 v68, 16, v32
    v_lshlrev_b32 v68, 2, v68
    ds_add_rtn_u32 v76, v68, v9 offset:62208
    s_mov_b64 exec, s[50:51]
    s_cbranch_execz K2_at_done
    v_lshrrev_b32 v69, 16, v34
    v_lshlrev_b32 v69, 2, v69
    ds_add_rtn_u32 v77, v69, v9 offset:62208
    s_mov_b64 exec, s[52:53]
    s_cbranch_execz K2_at_done
    v_lshrrev_b32 v70, 16, v36
    v_lshlrev_b32 v70, 2, v70
    ds_add_rtn_u32 v78, v70, v9 offset:62208
    s_mov_b64 exec, s[54:55]
    s_cbranch_execz K2_at_done
    v_lshrrev_b32 v71, 16, v38
    v_lshlrev_b32 v71, 2, v71
    ds_add_rtn_u32 v79, v71, v9 offset:62208
K2_at_done:
    s_mov_b64 exec, -1
    s_waitcnt lgkmcnt(0)
    s_barrier
    v_lshlrev_b32 v3, 2, v1
    ds_read_b32 v80, v3 offset:62208
    v_mov_b32 v59, 62724
    ds_read_b32 v60, v59
    s_waitcnt lgkmcnt(0)
    v_readfirstlane_b32 s62, v60
    v_add_u32 v81, 1, v80
    v_lshrrev_b32 v81, 1, v81
    v_max_u32 v81, 1, v81
    v_cmp_gt_u32 vcc, s101, v1
    s_nop 1
    v_cndmask_b32 v81, 0, v81, vcc
    v_mov_b32 v82, v81
    s_nop 1
    v_add_u32_dpp v82, v82, v82 row_shr:1 row_mask:0xf bank_mask:0xf bound_ctrl:0
    s_nop 1
    v_add_u32_dpp v82, v82, v82 row_shr:2 row_mask:0xf bank_mask:0xf bound_ctrl:0
    s_nop 1
    v_add_u32_dpp v82, v82, v82 row_shr:4 row_mask:0xf bank_mask:0xf bound_ctrl:0
    s_nop 1
    v_add_u32_dpp v82, v82, v82 row_shr:8 row_mask:0xf bank_mask:0xf bound_ctrl:0
    s_nop 1
    v_add_u32_dpp v82, v82, v82 row_bcast:15 row_mask:0xa bank_mask:0xf
    s_nop 1
    v_add_u32_dpp v82, v82, v82 row_bcast:31 row_mask:0xc bank_mask:0xf
    s_nop 1
    v_readlane_b32 s64, v82, 63
    v_sub_u32 v83, v82, v81
    s_cmp_lg_u32 s62, 0
    s_cbranch_scc1 K2_lists_done
    s_cmp_lg_u32 s3, 0
    s_cbranch_scc1 K2_noinfo
    ds_write_b32 v3, v80 offset:62464
    v_lshlrev_b32 v84, 1, v83
    v_lshlrev_b32 v85, 1, v81
    v_add_u32 v86, v84, v85
    v_subrev_u32 v86, 1, v86
    v_lshlrev_b32 v86, 3, v86
    v_cmp_lt_u32 vcc, v80, v85
    v_mov_b32 v88, 10048
    v_mov_b32 v89, 0
    s_mov_b64 exec, vcc
    ds_write_b64 v86, v[88:89] offset:62976
    v_add_u32 v87, 1, v80
    v_cmp_lt_u32 vcc, v87, v85
    v_subrev_u32 v86, 8, v86
    s_mov_b64 exec, vcc
    ds_write_b64 v86, v[88:89] offset:62976
    s_mov_b64 exec, -1
K2_noinfo:
    v_lshlrev_b32 v84, 1, v83
    s_cmp_ge_u32 s3, 8
    s_cbranch_scc1 K2_lists_done
    s_cmp_eq_u64 s[40:41], 0
    s_cbranch_scc1 K2_bp_done
    v_and_b32 v64, 0xfc, v64
    ds_bpermute_b32 v40, v64, v84
    s_cmp_eq_u64 s[42:43], 0
    s_cbranch_scc1 K2_bp_done
    v_and_b32 v65, 0xfc, v65
    ds_bpermute_b32 v41, v65, v84
    s_cmp_eq_u64 s[44:45], 0
    s_cbranch_scc1 K2_bp_done
    v_and_b32 v66, 0xfc, v66
    ds_bpermute_b32 v42, v66, v84
    s_cmp_eq_u64 s[46:47], 0
    s_cbranch_scc1 K2_bp_done
    v_and_b32 v67, 0xfc, v67
    ds_bpermute_b32 v43, v67, v84
    s_cmp_eq_u64 s[48:49], 0
    s_cbranch_scc1 K2_bp_done
    v_and_b32 v68, 0xfc, v68
    ds_bpermute_b32 v44, v68, v84
    s_cmp_eq_u64 s[50:51], 0
    s_cbranch_scc1 K2_bp_done
    v_and_b32 v69, 0xfc, v69
    ds_bpermute_b32 v45, v69, v84
    s_cmp_eq_u64 s[52:53], 0
    s_cbranch_scc1 K2_bp_done
    v_and_b32 v70, 0xfc, v70
    ds_bpermute_b32 v46, v70, v84
    s_cmp_eq_u64 s[54:55], 0
    s_cbranch_scc1 K2_bp_done
    v_and_b32 v71, 0xfc, v71
    ds_bpermute_b32 v47, v71, v84
K2_bp_done:
    s_waitcnt lgkmcnt(0)
    s_mov_b64 exec, s[40:41]
    s_cbranch_execz K2_lists_done
    v_add_u32 v40, v40, v72
    v_lshlrev_b32 v40, 3, v40
    v_and_b32 v24, 0xffff, v24
    ds_write_b64 v40, v[24:25] offset:62976
    s_mov_b64 exec, s[42:43]
    s_cbranch_execz K2_lists_done
    v_add_u32 v41, v41, v73
    v_lshlrev_b32 v41, 3, v41
    v_and_b32 v26, 0xffff, v26
    ds_write_b64 v41, v[26:27] offset:62976
    s_mov_b64 exec, s[44:45]
    s_cbranch_execz K2_lists_done
    v_add_u32 v42, v42, v74
    v_lshlrev_b32 v42, 3, v42
    v_and_b32 v28, 0xffff, v28
    ds_write_b64 v42, v[28:29] offset:62976
    s_mov_b64 exec, s[46:47]
    s_cbranch_execz K2_lists_done
    v_add_u32 v43, v43, v75
    v_lshlrev_b32 v43, 3, v43
    v_and_b32 v30, 0xffff, v30
    ds_write_b64 v43, v[30:31] offset:62976
    s_mov_b64 exec, s[48:49]
    s_cbranch_execz K2_lists_done
    v_add_u32 v44, v44, v76
    v_lshlrev_b32 v44, 3, v44
    v_and_b32 v32, 0xffff, v32
    ds_write_b64 v44, v[32:33] offset:62976
    s_mov_b64 exec, s[50:51]
    s_cbranch_execz K2_lists_done
    v_add_u32 v45, v45, v77
    v_lshlrev_b32 v45, 3, v45
    v_and_b32 v34, 0xffff, v34
    ds_write_b64 v45, v[34:35] offset:62976
    s_mov_b64 exec, s[52:53]
    s_cbranch_execz K2_lists_done
    v_add_u32 v46, v46, v78
    v_lshlrev_b32 v46, 3, v46
    v_and_b32 v36, 0xffff, v36
    ds_write_b64 v46, v[36:37] offset:62976
    s_mov_b64 exec, s[54:55]
    s_cbranch_execz K2_lists_done
    v_add_u32 v47, v47, v79
    v_lshlrev_b32 v47, 3, v47
    v_and_b32 v38, 0xffff, v38
    ds_write_b64 v47, v[38:39] offset:62976
K2_lists_done:
    s_mov_b64 exec, -1
    s_mul_i32 s65, s64, s3
    s_lshr_b32 s65, s65, 4
    s_add_u32 s66, s3, 1
    s_mul_i32 s66, s64, s66
    s_lshr_b32 s66, s66, 4
    v_cmp_ge_u32 vcc, s65, v82
    s_bcnt1_i32_b64 s24, vcc
    s_nop 3
    v_readlane_b32 s67, v83, s24
    v_readlane_b32 s68, v81, s24
    v_readlane_b32 s37, v80, s24
    v_lshrrev_b32 v5, 5, v1
    v_lshl_add_u32 v6, v5, 3, v2
    v_lshrrev_b32 v7, 1, v6
    s_getpc_b64 s[32:33]
K2_pc:
    s_add_u32 s32, s32, K2_switch-K2_pc
    s_addc_u32 s33, s33, 0
    s_waitcnt lgkmcnt(0)
    s_barrier
    s_mov_b32 s58, -1
    s_mov_b32 s97, 0
    s_mov_b32 s59, 0
    s_cmp_lg_u32 s62, 0
    s_cbranch_scc1 K2_slow_start
    s_cmp_gt_u32 s65, s67
    s_cselect_b32 s69, 1, 0
    s_add_u32 s67, s67, s68
    s_min_u32 s68, s67, s66
    s_sub_u32 s61, s68, s65
    s_mov_b64 s[38:39], -1
    s_cmp_lt_u32 s68, s67
    s_cbranch_scc1 K2_lm0
    s_bitcmp1_b32 s37, 0
    s_cselect_b32 s39, 0, -1
    s_cmp_eq_u32 s37, 0
    s_cselect_b32 s38, 0, -1
    s_cselect_b32 s39, 0, s39
K2_lm0:
    s_sub_u32 s63, s66, s65
    s_mov_b32 s60, s63
    s_lshr_b32 s57, s63, 3
    s_lshr_b32 s56, s63, 2
    s_lshr_b32 s55, s63, 1
    s_sub_u32 s57, s57, 4
    s_sub_u32 s56, s56, 4
    s_sub_u32 s55, s55, 4
    s_max_i32 s57, s57, 0
    s_setprio 3
    s_lshl_b32 s26, s65, 4
    s_add_u32 s26, s26, 62976
    v_lshl_add_u32 v4, v5, 3, s26
    s_mul_i32 s25, s24, 1040
    s_add_u32 s25, s25, 12288
    v_add_u32 v3, s25, v2
    ds_read_b128 v[8:11], v3
    ds_read_b32 v40, v4 offset:0
    ds_read_b32 v48, v4 offset:4
    v_mov_b32 v41, v2
    ds_read_b32 v42, v4 offset:16
    ds_read_b32 v49, v4 offset:20
    v_mov_b32 v43, v2
    ds_read_b32 v44, v4 offset:32
    ds_read_b32 v50, v4 offset:36
    v_mov_b32 v45, v2
    ds_read_b32 v46, v4 offset:48
    ds_read_b32 v51, v4 offset:52
    v_mov_b32 v47, v2
    v_add_u32 v4, 64, v4
    v_mov_b32 v16, 0
    v_mov_b32 v17, 0
    v_mov_b32 v18, 0
    v_mov_b32 v19, 0
    v_mov_b32 v20, 0
    v_mov_b32 v21, 0
    v_mov_b32 v22, 0
    v_mov_b32 v23, 0
    s_mov_b32 s16, s8
    s_and_b32 s17, s9, 0xffff
    s_or_b32 s17, s17, 0x02000000
    s_mov_b32 s18, 10049
    s_mov_b32 s19, 0x00020000
    s_waitcnt lgkmcnt(0)
    buffer_load_dwordx4 v[24:27], v[40:41], s[16:19], 0 idxen offen
    s_sub_u32 s63, s63, 1
    s_cmp_eq_u32 s63, 0
    s_cbranch_scc1 K2_DRW_0
    buffer_load_dwordx4 v[28:31], v[42:43], s[16:19], 0 idxen offen
    s_sub_u32 s63, s63, 1
    s_cmp_eq_u32 s63, 0
    s_cbranch_scc1 K2_DRW_0
    buffer_load_dwordx4 v[32:35], v[44:45], s[16:19], 0 idxen offen
    s_sub_u32 s63, s63, 1
    s_cmp_eq_u32 s63, 0
    s_cbranch_scc1 K2_DRW_0
    buffer_load_dwordx4 v[36:39], v[46:47], s[16:19], 0 idxen offen
    s_sub_u32 s63, s63, 1
K2_S0:
    s_cmp_gt_u32 s63, s55
    s_cbranch_scc1 K2_pr0
    s_setprio 2
    s_cmp_gt_u32 s63, s56
    s_cbranch_scc1 K2_pr0
    s_setprio 1
    s_cmp_gt_u32 s63, s57
    s_cbranch_scc1 K2_pr0
    s_setprio 0
K2_pr0:
    s_cmp_eq_u32 s63, 0
    s_cbranch_scc1 K2_DRW_0
    s_sub_u32 s63, s63, 1
    s_waitcnt vmcnt(3)
    v_pk_fma_f32 v[52:53], v[48:49], v[12:13], v[8:9] op_sel:[0,0,0] op_sel_hi:[0,1,1]
    v_pk_fma_f32 v[54:55], v[48:49], v[14:15], v[10:11] op_sel:[0,0,0] op_sel_hi:[0,1,1]
    ds_read_b32 v40, v4 offset:0
    ds_read_b32 v48, v4 offset:4
    v_exp_f32 v52, v52
    v_exp_f32 v53, v53
    v_exp_f32 v54, v54
    v_exp_f32 v55, v55
    s_cmp_eq_u32 s61, 1
    v_pk_fma_f32 v[52:53], v[52:53], v[24:25], 1.0 op_sel_hi:[1,1,0]
    v_pk_fma_f32 v[54:55], v[54:55], v[26:27], 1.0 op_sel_hi:[1,1,0]
    v_rcp_f32 v52, v52
    v_rcp_f32 v53, v53
    v_rcp_f32 v54, v54
    v_rcp_f32 v55, v55
    s_cselect_b64 exec, s[38:39], -1
    s_sub_u32 s61, s61, 1
    v_pk_add_f32 v[20:21], v[20:21], v[52:53]
    v_pk_add_f32 v[22:23], v[22:23], v[54:55]
    v_fma_mix_f32 v16, v52, v24, v16 op_sel_hi:[0,1,0]
    v_fma_mix_f32 v17, v53, v25, v17 op_sel_hi:[0,1,0]
    v_fma_mix_f32 v18, v54, v26, v18 op_sel_hi:[0,1,0]
    v_fma_mix_f32 v19, v55, v27, v19 op_sel_hi:[0,1,0]
    s_mov_b64 exec, -1
    s_waitcnt lgkmcnt(0)
    buffer_load_dwordx4 v[24:27], v[40:41], s[16:19], 0 idxen offen
    s_cmp_eq_u32 s61, 0
    s_cbranch_scc1 K2_CS0
K2_S1:
    s_cmp_eq_u32 s63, 0
    s_cbranch_scc1 K2_DRW_1
    s_sub_u32 s63, s63, 1
    s_waitcnt vmcnt(3)
    v_pk_fma_f32 v[52:53], v[48:49], v[12:13], v[8:9] op_sel:[1,0,0] op_sel_hi:[1,1,1]
    v_pk_fma_f32 v[54:55], v[48:49], v[14:15], v[10:11] op_sel:[1,0,0] op_sel_hi:[1,1,1]
    ds_read_b32 v42, v4 offset:16
    ds_read_b32 v49, v4 offset:20
    v_exp_f32 v52, v52
    v_exp_f32 v53, v53
    v_exp_f32 v54, v54
    v_exp_f32 v55, v55
    s_cmp_eq_u32 s61, 1
    v_pk_fma_f32 v[52:53], v[52:53], v[28:29], 1.0 op_sel_hi:[1,1,0]
    v_pk_fma_f32 v[54:55], v[54:55], v[30:31], 1.0 op_sel_hi:[1,1,0]
    v_rcp_f32 v52, v52
    v_rcp_f32 v53, v53
    v_rcp_f32 v54, v54
    v_rcp_f32 v55, v55
    s_cselect_b64 exec, s[38:39], -1
    s_sub_u32 s61, s61, 1
    v_pk_add_f32 v[20:21], v[20:21], v[52:53]
    v_pk_add_f32 v[22:23], v[22:23], v[54:55]
    v_fma_mix_f32 v16, v52, v28, v16 op_sel_hi:[0,1,0]
    v_fma_mix_f32 v17, v53, v29, v17 op_sel_hi:[0,1,0]
    v_fma_mix_f32 v18, v54, v30, v18 op_sel_hi:[0,1,0]
    v_fma_mix_f32 v19, v55, v31, v19 op_sel_hi:[0,1,0]
    s_mov_b64 exec, -1
    s_waitcnt lgkmcnt(0)
    buffer_load_dwordx4 v[28:31], v[42:43], s[16:19], 0 idxen offen
    s_cmp_eq_u32 s61, 0
    s_cbranch_scc1 K2_CS1
K2_S2:
    s_cmp_gt_u32 s63, s55
    s_cbranch_scc1 K2_pr2
    s_setprio 2
    s_cmp_gt_u32 s63, s56
    s_cbranch_scc1 K2_pr2
    s_setprio 1
    s_cmp_gt_u32 s63, s57
    s_cbranch_scc1 K2_pr2
    s_setprio 0
K2_pr2:
    s_cmp_eq_u32 s63, 0
    s_cbranch_scc1 K2_DRW_2
    s_sub_u32 s63, s63, 1
    s_waitcnt vmcnt(3)
    v_pk_fma_f32 v[52:53], v[50:51], v[12:13], v[8:9] op_sel:[0,0,0] op_sel_hi:[0,1,1]
    v_pk_fma_f32 v[54:55], v[50:51], v[14:15], v[10:11] op_sel:[0,0,0] op_sel_hi:[0,1,1]
    ds_read_b32 v44, v4 offset:32
    ds_read_b32 v50, v4 offset:36
    v_exp_f32 v52, v52
    v_exp_f32 v53, v53
    v_exp_f32 v54, v54
    v_exp_f32 v55, v55
    s_cmp_eq_u32 s61, 1
    v_pk_fma_f32 v[52:53], v[52:53], v[32:33], 1.0 op_sel_hi:[1,1,0]
    v_pk_fma_f32 v[54:55], v[54:55], v[34:35], 1.0 op_sel_hi:[1,1,0]
    v_rcp_f32 v52, v52
    v_rcp_f32 v53, v53
    v_rcp_f32 v54, v54
    v_rcp_f32 v55, v55
    s_cselect_b64 exec, s[38:39], -1
    s_sub_u32 s61, s61, 1
    v_pk_add_f32 v[20:21], v[20:21], v[52:53]
    v_pk_add_f32 v[22:23], v[22:23], v[54:55]
    v_fma_mix_f32 v16, v52, v32, v16 op_sel_hi:[0,1,0]
    v_fma_mix_f32 v17, v53, v33, v17 op_sel_hi:[0,1,0]
    v_fma_mix_f32 v18, v54, v34, v18 op_sel_hi:[0,1,0]
    v_fma_mix_f32 v19, v55, v35, v19 op_sel_hi:[0,1,0]
    s_mov_b64 exec, -1
    s_waitcnt lgkmcnt(0)
    buffer_load_dwordx4 v[32:35], v[44:45], s[16:19], 0 idxen offen
    s_cmp_eq_u32 s61, 0
    s_cbranch_scc1 K2_CS2
K2_S3:
    s_cmp_eq_u32 s63, 0
    s_cbranch_scc1 K2_DRW_3
    s_sub_u32 s63, s63, 1
    s_waitcnt vmcnt(3)
    v_pk_fma_f32 v[52:53], v[50:51], v[12:13], v[8:9] op_sel:[1,0,0] op_sel_hi:[1,1,1]
    v_pk_fma_f32 v[54:55], v[50:51], v[14:15], v[10:11] op_sel:[1,0,0] op_sel_hi:[1,1,1]
    ds_read_b32 v46, v4 offset:48
    ds_read_b32 v51, v4 offset:52
    v_exp_f32 v52, v52
    v_exp_f32 v53, v53
    v_exp_f32 v54, v54
    v_exp_f32 v55, v55
    s_cmp_eq_u32 s61, 1
    v_pk_fma_f32 v[52:53], v[52:53], v[36:37], 1.0 op_sel_hi:[1,1,0]
    v_pk_fma_f32 v[54:55], v[54:55], v[38:39], 1.0 op_sel_hi:[1,1,0]
    v_rcp_f32 v52, v52
    v_rcp_f32 v53, v53
    v_rcp_f32 v54, v54
    v_rcp_f32 v55, v55
    s_cselect_b64 exec, s[38:39], -1
    s_sub_u32 s61, s61, 1
    v_pk_add_f32 v[20:21], v[20:21], v[52:53]
    v_pk_add_f32 v[22:23], v[22:23], v[54:55]
    v_fma_mix_f32 v16, v52, v36, v16 op_sel_hi:[0,1,0]
    v_fma_mix_f32 v17, v53, v37, v17 op_sel_hi:[0,1,0]
    v_fma_mix_f32 v18, v54, v38, v18 op_sel_hi:[0,1,0]
    v_fma_mix_f32 v19, v55, v39, v19 op_sel_hi:[0,1,0]
    s_mov_b64 exec, -1
    s_waitcnt lgkmcnt(0)
    buffer_load_dwordx4 v[36:39], v[46:47], s[16:19], 0 idxen offen
    v_add_u32 v4, 64, v4
    s_cmp_eq_u32 s61, 0
    s_cbranch_scc1 K2_CS3
    s_branch K2_S0
K2_CS0:
    s_swappc_b64 s[30:31], s[32:33]
    s_branch K2_S1
K2_CS1:
    s_swappc_b64 s[30:31], s[32:33]
    s_branch K2_S2
K2_CS2:
    s_swappc_b64 s[30:31], s[32:33]
    s_branch K2_S3
K2_CS3:
    s_swappc_b64 s[30:31], s[32:33]
    s_branch K2_S0
K2_DRW_0:
    s_waitcnt vmcnt(0)
    s_branch K2_DR0
K2_DRW_1:
    s_waitcnt vmcnt(0)
    s_branch K2_DR1
K2_DRW_2:
    s_waitcnt vmcnt(0)
    s_branch K2_DR2
K2_DRW_3:
    s_waitcnt vmcnt(0)
    s_branch K2_DR3
K2_DR0:
    v_pk_fma_f32 v[52:53], v[48:49], v[12:13], v[8:9] op_sel:[0,0,0] op_sel_hi:[0,1,1]
    v_pk_fma_f32 v[54:55], v[48:49], v[14:15], v[10:11] op_sel:[0,0,0] op_sel_hi:[0,1,1]
    v_exp_f32 v52, v52
    v_exp_f32 v53, v53
    v_exp_f32 v54, v54
    v_exp_f32 v55, v55
    s_cmp_eq_u32 s61, 1
    v_pk_fma_f32 v[52:53], v[52:53], v[24:25], 1.0 op_sel_hi:[1,1,0]
    v_pk_fma_f32 v[54:55], v[54:55], v[26:27], 1.0 op_sel_hi:[1,1,0]
    v_rcp_f32 v52, v52
    v_rcp_f32 v53, v53
    v_rcp_f32 v54, v54
    v_rcp_f32 v55, v55
    s_cselect_b64 exec, s[38:39], -1
    s_sub_u32 s61, s61, 1
    v_pk_add_f32 v[20:21], v[20:21], v[52:53]
    v_pk_add_f32 v[22:23], v[22:23], v[54:55]
    v_fma_mix_f32 v16, v52, v24, v16 op_sel_hi:[0,1,0]
    v_fma_mix_f32 v17, v53, v25, v17 op_sel_hi:[0,1,0]
    v_fma_mix_f32 v18, v54, v26, v18 op_sel_hi:[0,1,0]
    v_fma_mix_f32 v19, v55, v27, v19 op_sel_hi:[0,1,0]
    s_mov_b64 exec, -1
    s_cmp_eq_u32 s61, 0
    s_cbranch_scc1 K2_CD0
K2_DR1:
    v_pk_fma_f32 v[52:53], v[48:49], v[12:13], v[8:9] op_sel:[1,0,0] op_sel_hi:[1,1,1]
    v_pk_fma_f32 v[54:55], v[48:49], v[14:15], v[10:11] op_sel:[1,0,0] op_sel_hi:[1,1,1]
    v_exp_f32 v52, v52
    v_exp_f32 v53, v53
    v_exp_f32 v54, v54
    v_exp_f32 v55, v55
    s_cmp_eq_u32 s61, 1
    v_pk_fma_f32 v[52:53], v[52:53], v[28:29], 1.0 op_sel_hi:[1,1,0]
    v_pk_fma_f32 v[54:55], v[54:55], v[30:31], 1.0 op_sel_hi:[1,1,0]
    v_rcp_f32 v52, v52
    v_rcp_f32 v53, v53
    v_rcp_f32 v54, v54
    v_rcp_f32 v55, v55
    s_cselect_b64 exec, s[38:39], -1
    s_sub_u32 s61, s61, 1
    v_pk_add_f32 v[20:21], v[20:21], v[52:53]
    v_pk_add_f32 v[22:23], v[22:23], v[54:55]
    v_fma_mix_f32 v16, v52, v28, v16 op_sel_hi:[0,1,0]
    v_fma_mix_f32 v17, v53, v29, v17 op_sel_hi:[0,1,0]
    v_fma_mix_f32 v18, v54, v30, v18 op_sel_hi:[0,1,0]
    v_fma_mix_f32 v19, v55, v31, v19 op_sel_hi:[0,1,0]
    s_mov_b64 exec, -1
    s_cmp_eq_u32 s61, 0
    s_cbranch_scc1 K2_CD1
K2_DR2:
    v_pk_fma_f32 v[52:53], v[50:51], v[12:13], v[8:9] op_sel:[0,0,0] op_sel_hi:[0,1,1]
    v_pk_fma_f32 v[54:55], v[50:51], v[14:15], v[10:11] op_sel:[0,0,0] op_sel_hi:[0,1,1]
    v_exp_f32 v52, v52
    v_exp_f32 v53, v53
    v_exp_f32 v54, v54
    v_exp_f32 v55, v55
    s_cmp_eq_u32 s61, 1
    v_pk_fma_f32 v[52:53], v[52:53], v[32:33], 1.0 op_sel_hi:[1,1,0]
    v_pk_fma_f32 v[54:55], v[54:55], v[34:35], 1.0 op_sel_hi:[1,1,0]
    v_rcp_f32 v52, v52
    v_rcp_f32 v53, v53
    v_rcp_f32 v54, v54
    v_rcp_f32 v55, v55
    s_cselect_b64 exec, s[38:39], -1
    s_sub_u32 s61, s61, 1
    v_pk_add_f32 v[20:21], v[20:21], v[52:53]
    v_pk_add_f32 v[22:23], v[22:23], v[54:55]
    v_fma_mix_f32 v16, v52, v32, v16 op_sel_hi:[0,1,0]
    v_fma_mix_f32 v17, v53, v33, v17 op_sel_hi:[0,1,0]
    v_fma_mix_f32 v18, v54, v34, v18 op_sel_hi:[0,1,0]
    v_fma_mix_f32 v19, v55, v35, v19 op_sel_hi:[0,1,0]
    s_mov_b64 exec, -1
    s_cmp_eq_u32 s61, 0
    s_cbranch_scc1 K2_CD2
K2_DR3:
    v_pk_fma_f32 v[52:53], v[50:51], v[12:13], v[8:9] op_sel:[1,0,0] op_sel_hi:[1,1,1]
    v_pk_fma_f32 v[54:55], v[50:51], v[14:15], v[10:11] op_sel:[1,0,0] op_sel_hi:[1,1,1]
    v_exp_f32 v52, v52
    v_exp_f32 v53, v53
    v_exp_f32 v54, v54
    v_exp_f32 v55, v55
    s_cmp_eq_u32 s61, 1
    v_pk_fma_f32 v[52:53], v[52:53], v[36:37], 1.0 op_sel_hi:[1,1,0]
    v_pk_fma_f32 v[54:55], v[54:55], v[38:39], 1.0 op_sel_hi:[1,1,0]
    v_rcp_f32 v52, v52
    v_rcp_f32 v53, v53
    v_rcp_f32 v54, v54
    v_rcp_f32 v55, v55
    s_cselect_b64 exec, s[38:39], -1
    s_sub_u32 s61, s61, 1
    v_pk_add_f32 v[20:21], v[20:21], v[52:53]
    v_pk_add_f32 v[22:23], v[22:23], v[54:55]
    v_fma_mix_f32 v16, v52, v36, v16 op_sel_hi:[0,1,0]
    v_fma_mix_f32 v17, v53, v37, v17 op_sel_hi:[0,1,0]
    v_fma_mix_f32 v18, v54, v38, v18 op_sel_hi:[0,1,0]
    v_fma_mix_f32 v19, v55, v39, v19 op_sel_hi:[0,1,0]
    s_mov_b64 exec, -1
    s_cmp_eq_u32 s61, 0
    s_cbranch_scc1 K2_CD3
    s_branch K2_DR0
K2_CD0:
    s_swappc_b64 s[30:31], s[32:33]
    s_branch K2_DR1
K2_CD1:
    s_swappc_b64 s[30:31], s[32:33]
    s_branch K2_DR2
K2_CD2:
    s_swappc_b64 s[30:31], s[32:33]
    s_branch K2_DR3
K2_CD3:
    s_swappc_b64 s[30:31], s[32:33]
    s_branch K2_DR0
K2_switch:
    s_mul_i32 s25, s24, 1040
    s_add_u32 s25, s25, 12288
    v_add_u32 v3, s25, v6
    ds_read_b64 v[62:63], v3 offset:512
    s_and_b32 s26, s24, 15
    s_lshl_b32 s26, s26, 4
    s_lshl_b32 s27, s24, 8
    v_xor_b32 v3, s26, v7
    v_add_u32 v3, s27, v3
    ds_read_b32 v64, v3 offset:0
    v_permlane32_swap_b32 v16, v18
    v_permlane32_swap_b32 v17, v19
    v_permlane32_swap_b32 v20, v22
    v_permlane32_swap_b32 v21, v23
    s_nop 1
    v_pk_add_f32 v[16:17], v[16:17], v[18:19]
    v_pk_add_f32 v[18:19], v[20:21], v[22:23]
    s_cmp_lt_u32 s68, s67
    s_cbranch_scc1 K2_sw_tail
    s_cmp_lg_u32 s69, 0
    s_cbranch_scc1 K2_sw_head
K2_epi:
    s_mov_b32 s36, 0x358637bd
    v_add_f32 v18, s36, v18
    v_add_f32 v19, s36, v19
    v_rcp_f32 v18, v18
    v_rcp_f32 v19, v19
    s_waitcnt lgkmcnt(0)
    v_lshlrev_b32 v20, 16, v64
    v_and_b32 v21, 0xffff0000, v64
    v_pk_fma_f32 v[16:17], v[16:17], v[18:19], v[62:63]
    v_mul_f32 v22, 0, v16
    v_mul_f32 v23, 0, v17
    v_cmp_lt_f32 vcc, 0, v16
    v_cmp_lt_f32 s[40:41], 0, v17
    s_add_u32 s34, s100, s24
    s_lshl_b32 s34, s34, 8
    v_cndmask_b32 v16, v22, v16, vcc
    v_cndmask_b32 v17, v23, v17, s[40:41]
    v_pk_add_f32 v[16:17], v[16:17], v[20:21]
    v_cvt_pk_bf16_f32 v16, v16, v17
    buffer_store_dword v16, v7, s[20:23], s34 offen sc0 sc1
    s_cmp_lg_u32 s59, 0
    s_cbranch_scc1 K2_final_ret
K2_sw_next:
    s_cmp_ge_u32 s68, s66
    s_cbranch_scc1 K2_wave_done
    s_add_u32 s24, s24, 1
    s_mov_b32 s69, 0
    s_lshl_b32 s26, s24, 2
    v_mov_b32 v3, s26
    ds_read_b32 v60, v3 offset:62464
    s_add_u32 s25, s25, 1040
    v_add_u32 v3, s25, v2
    ds_read_b128 v[8:11], v3
    v_mov_b32 v16, 0
    v_mov_b32 v17, 0
    v_mov_b32 v18, 0
    v_mov_b32 v19, 0
    v_mov_b32 v20, 0
    v_mov_b32 v21, 0
    v_mov_b32 v22, 0
    v_mov_b32 v23, 0
    s_waitcnt lgkmcnt(0)
    v_readfirstlane_b32 s37, v60
    s_add_u32 s26, s37, 1
    s_lshr_b32 s26, s26, 1
    s_max_u32 s26, s26, 1
    s_add_u32 s67, s67, s26
    s_mov_b32 s27, s68
    s_min_u32 s68, s67, s66
    s_sub_u32 s61, s68, s27
    s_mov_b64 s[38:39], -1
    s_cmp_lt_u32 s68, s67
    s_cbranch_scc1 K2_lm1
    s_bitcmp1_b32 s37, 0
    s_cselect_b32 s39, 0, -1
    s_cmp_eq_u32 s37, 0
    s_cselect_b32 s38, 0, -1
    s_cselect_b32 s39, 0, s39
K2_lm1:
    s_setpc_b64 s[30:31]
K2_sw_tail:
    s_lshl_b32 s26, s3, 11
    s_add_u32 s26, s26, 97792
    v_lshl_add_u32 v3, v1, 4, s26
    ds_write_b128 v3, v[16:19]
    s_lshl_b32 s26, s3, 2
    v_mov_b32 v3, s26
    v_mov_b32 v20, s69
    ds_write_b32 v3, v20 offset:62784
    s_branch K2_wave_done
K2_sw_head:
    s_lshl_b32 s26, s3, 11
    s_add_u32 s26, s26, 96768
    v_lshl_add_u32 v3, v1, 4, s26
    ds_write_b128 v3, v[16:19]
    s_mov_b32 s58, s24
    s_waitcnt lgkmcnt(0)
    s_branch K2_sw_next
K2_wave_done:
    s_waitcnt lgkmcnt(0)
    s_barrier
    s_cmp_eq_u32 s58, -1
    s_cbranch_scc1 K2_done
    s_mov_b32 s24, s58
    s_mul_i32 s25, s24, 1040
    s_add_u32 s25, s25, 12288
    v_add_u32 v3, s25, v6
    ds_read_b64 v[62:63], v3 offset:512
    s_and_b32 s26, s24, 15
    s_lshl_b32 s26, s26, 4
    s_lshl_b32 s27, s24, 8
    v_xor_b32 v3, s26, v7
    v_add_u32 v3, s27, v3
    ds_read_b32 v64, v3 offset:0
    s_lshl_b32 s26, s3, 11
    s_add_u32 s26, s26, 96768
    v_lshl_add_u32 v3, v1, 4, s26
    ds_read_b128 v[16:19], v3
    s_mov_b32 s27, s3
K2_fin_loop:
    s_sub_u32 s27, s27, 1
    s_lshl_b32 s26, s27, 11
    s_add_u32 s26, s26, 97792
    v_lshl_add_u32 v3, v1, 4, s26
    ds_read_b128 v[20:23], v3
    s_lshl_b32 s26, s27, 2
    v_mov_b32 v3, s26
    ds_read_b32 v60, v3 offset:62784
    s_waitcnt lgkmcnt(0)
    v_pk_add_f32 v[16:17], v[16:17], v[20:21]
    v_pk_add_f32 v[18:19], v[18:19], v[22:23]
    v_readfirstlane_b32 s26, v60
    s_cmp_lg_u32 s26, 0
    s_cbranch_scc1 K2_fin_loop
    s_mov_b32 s59, 1
    s_branch K2_epi
K2_final_ret:
    s_cmp_eq_u32 s59, 1
    s_cbranch_scc1 K2_done
    s_setpc_b64 s[30:31]
K2_slow_start:
    s_mov_b32 s24, s3
K2_slow_node:
    s_cmp_ge_u32 s24, s101
    s_cbranch_scc1 K2_done
    s_mul_i32 s25, s24, 1040
    s_add_u32 s25, s25, 12288
    v_add_u32 v3, s25, v2
    ds_read_b128 v[8:11], v3
    v_mov_b32 v16, 0
    v_mov_b32 v17, 0
    v_mov_b32 v18, 0
    v_mov_b32 v19, 0
    v_mov_b32 v20, 0
    v_mov_b32 v21, 0
    v_mov_b32 v22, 0
    v_mov_b32 v23, 0
    s_mov_b32 s50, -1
    s_mov_b32 s51, 0
    s_mov_b32 s53, 0
    s_mul_i32 s54, s3, 528
    s_add_u32 s54, s54, 62976
K2_slow_next:
    s_cmp_lt_u32 s51, s53
    s_cbranch_scc1 K2_slow_seg
    s_add_u32 s50, s50, 1
    s_cmp_ge_u32 s50, 64
    s_cbranch_scc1 K2_slow_fin
    s_lshl_b32 s55, s2, 8
    s_lshl_b32 s56, s50, 2
    s_add_u32 s55, s55, s56
    s_add_u32 s55, s55, 5373952
    v_mov_b32 v3, 0
    buffer_load_dword v60, v3, s[12:15], s55 offen
    s_waitcnt vmcnt(0)
    v_readfirstlane_b32 s52, v60
    s_lshr_b32 s53, s52, 16
    s_and_b32 s52, s52, 0xffff
    s_mov_b32 s51, 0
    s_branch K2_slow_next
K2_slow_seg:
    v_add_u32 v3, s51, v1
    v_cmp_gt_u32 vcc, s53, v3
    s_mul_i32 s55, s50, 40000
    s_add_u32 s55, s55, 5505024
    s_add_u32 s56, s52, s51
    s_lshl_b32 s56, s56, 3
    s_add_u32 s55, s55, s56
    v_lshlrev_b32 v3, 3, v1
    v_mov_b32 v26, -1
    v_mov_b32 v27, 0
    s_mov_b64 exec, vcc
    buffer_load_dwordx2 v[26:27], v3, s[12:15], s55 offen
    s_mov_b64 exec, -1
    s_add_u32 s51, s51, 64
    s_waitcnt vmcnt(0)
    v_lshrrev_b32 v3, 16, v26
    v_cmp_eq_u32 vcc, s24, v3
    s_bcnt1_i32_b64 s56, vcc
    v_mbcnt_lo_u32_b32 v3, vcc_lo, 0
    v_mbcnt_hi_u32_b32 v3, vcc_hi, v3
    v_lshl_add_u32 v3, v3, 3, s54
    v_and_b32 v26, 0xffff, v26
    s_lshl_b32 s57, s56, 3
    s_add_u32 s57, s57, s54
    v_mov_b32 v28, s57
    v_mov_b32 v30, 10048
    v_mov_b32 v31, 0
    s_mov_b64 exec, vcc
    ds_write_b64 v3, v[26:27]
    s_mov_b64 exec, 1
    ds_write_b64 v28, v[30:31]
    s_mov_b64 exec, -1
    s_add_u32 s61, s56, 1
    s_lshr_b32 s61, s61, 1
    v_lshl_add_u32 v4, v5, 3, s54
    s_waitcnt lgkmcnt(0)
K2_slow_it:
    s_cmp_eq_u32 s61, 0
    s_cbranch_scc1 K2_slow_next
    s_sub_u32 s61, s61, 1
    ds_read_b64 v[24:25], v4
    v_add_u32 v4, 16, v4
    s_mov_b32 s55, 8388608
    s_mov_b32 s56, 5324800
    s_waitcnt lgkmcnt(0)
    v_lshl_add_u32 v26, v24, 9, v2
    buffer_load_dwordx4 v[28:31], v26, s[12:15], 0 offen
    buffer_load_dwordx4 v[32:35], v26, s[12:15], s55 offen
    v_lshrrev_b32 v27, 6, v24
    v_lshlrev_b32 v27, 5, v27
    v_lshrrev_b32 v26, 6, v2
    v_lshl_add_u32 v27, v26, 2, v27
    buffer_load_dword v36, v27, s[12:15], s56 offen
    v_pk_fma_f32 v[40:41], v[24:25], v[12:13], v[8:9] op_sel:[1,0,0] op_sel_hi:[1,1,1]
    v_pk_fma_f32 v[42:43], v[24:25], v[14:15], v[10:11] op_sel:[1,0,0] op_sel_hi:[1,1,1]
    s_waitcnt vmcnt(0)
    v_cmp_ne_u32 s[40:41], 0, v36
    v_cmp_ne_u32 vcc, 10048, v24
    s_mov_b64 s[42:43], vcc
    v_exp_f32 v44, v40
    v_add_f32 v45, v40, v32
    v_exp_f32 v45, v45
    v_fma_f32 v44, v44, v28, 1.0
    v_add_f32 v45, 1.0, v45
    v_cvt_f32_f16 v46, v28
    v_lshlrev_b32 v47, 16, v32
    v_cndmask_b32 v44, v44, v45, s[40:41]
    v_cndmask_b32 v46, v46, v47, s[40:41]
    v_rcp_f32 v44, v44
    s_mov_b64 exec, s[42:43]
    v_add_f32 v20, v20, v44
    v_fma_f32 v16, v44, v46, v16
    s_mov_b64 exec, -1
    v_exp_f32 v44, v41
    v_add_f32 v45, v41, v33
    v_exp_f32 v45, v45
    v_fma_f32 v44, v44, v29, 1.0
    v_add_f32 v45, 1.0, v45
    v_cvt_f32_f16 v46, v29
    v_lshlrev_b32 v47, 16, v33
    v_cndmask_b32 v44, v44, v45, s[40:41]
    v_cndmask_b32 v46, v46, v47, s[40:41]
    v_rcp_f32 v44, v44
    s_mov_b64 exec, s[42:43]
    v_add_f32 v21, v21, v44
    v_fma_f32 v17, v44, v46, v17
    s_mov_b64 exec, -1
    v_exp_f32 v44, v42
    v_add_f32 v45, v42, v34
    v_exp_f32 v45, v45
    v_fma_f32 v44, v44, v30, 1.0
    v_add_f32 v45, 1.0, v45
    v_cvt_f32_f16 v46, v30
    v_lshlrev_b32 v47, 16, v34
    v_cndmask_b32 v44, v44, v45, s[40:41]
    v_cndmask_b32 v46, v46, v47, s[40:41]
    v_rcp_f32 v44, v44
    s_mov_b64 exec, s[42:43]
    v_add_f32 v22, v22, v44
    v_fma_f32 v18, v44, v46, v18
    s_mov_b64 exec, -1
    v_exp_f32 v44, v43
    v_add_f32 v45, v43, v35
    v_exp_f32 v45, v45
    v_fma_f32 v44, v44, v31, 1.0
    v_add_f32 v45, 1.0, v45
    v_cvt_f32_f16 v46, v31
    v_lshlrev_b32 v47, 16, v35
    v_cndmask_b32 v44, v44, v45, s[40:41]
    v_cndmask_b32 v46, v46, v47, s[40:41]
    v_rcp_f32 v44, v44
    s_mov_b64 exec, s[42:43]
    v_add_f32 v23, v23, v44
    v_fma_f32 v19, v44, v46, v19
    s_mov_b64 exec, -1
    s_branch K2_slow_it
K2_slow_fin:
    s_mov_b32 s69, 0
    s_mov_b32 s67, 0
    s_mov_b32 s68, 0
    s_mov_b32 s66, 1
    s_mov_b32 s59, 2
    s_getpc_b64 s[30:31]
K2_pc2:
    s_add_u32 s30, s30, K2_slow_ret-K2_pc2
    s_addc_u32 s31, s31, 0
    s_branch K2_switch
K2_slow_ret:
    s_add_u32 s24, s24, 16
    s_branch K2_slow_node
K2_done:
K2_exit:
    s_endpgm
.section .rodata,"a"
.p2align 6
.amdhsa_kernel prep_kernel
  .amdhsa_next_free_vgpr 160
  .amdhsa_next_free_sgpr 64
  .amdhsa_accum_offset 160
  .amdhsa_group_segment_fixed_size 0
  .amdhsa_kernarg_size 96
  .amdhsa_user_sgpr_count 2
  .amdhsa_user_sgpr_kernarg_segment_ptr 1
  .amdhsa_system_sgpr_workgroup_id_x 1
.end_amdhsa_kernel
.p2align 6
.amdhsa_kernel agg_kernel
  .amdhsa_next_free_vgpr 128
  .amdhsa_next_free_sgpr 102
  .amdhsa_accum_offset 128
  .amdhsa_group_segment_fixed_size 0
  .amdhsa_kernarg_size 96
  .amdhsa_user_sgpr_count 2
  .amdhsa_user_sgpr_kernarg_segment_ptr 1
  .amdhsa_system_sgpr_workgroup_id_x 1
.end_amdhsa_kernel
```
